```python
import torch

def _softmax(x, axis=-1):
    return torch.softmax(x, dim=axis)

def _gelu(x):
    return torch.nn.functional.gelu(x, approximate='tanh')

def _silu(x):
    return torch.nn.functional.silu(x)

def _sigmoid(x):
    return torch.sigmoid(x)

def _layernorm(x, axis=-1, eps=1e-05):
    m = x.mean(dim=axis, keepdim=True)
    v = x.var(dim=axis, keepdim=True, unbiased=False)
    return (x - m) / torch.sqrt(v + eps)

def _scatter_add(tgt, idx, src, axis=0):
    return tgt.clone().index_add_(axis, idx, src)

def _segment_sum(src, seg, n):
    out = torch.zeros((n,) + src.shape[1:], dtype=src.dtype)
    return out.index_add_(0, seg, src)

def _pad(x, pw):
    flat = tuple((v for pair in reversed(pw) for v in pair))
    return torch.nn.functional.pad(x, flat)
kernel_name = 'adaLN_cond__ssm_conv_h3__dense_activation_relu__prompt'

def setup_inputs():

    _w = lambda a: (lambda t: t.to(torch.bfloat16) if t.is_floating_point() else t)(torch.as_tensor(a))

    def _A_setup():
        B, S, D = (1, 2048, 512)
        ks = 4
        return {'q': _w((lambda *s: torch.randn(*s, dtype=torch.bfloat16) * 0.05)(B, S, D)), 'k': _w((lambda *s: torch.randn(*s, dtype=torch.bfloat16) * 0.8)(B, S, D)), 'v': _w((lambda *s: torch.randn(*s, dtype=torch.bfloat16) * 0.8)(B, S, D)), 'shift_k': _w((lambda *s: torch.randn(*s, dtype=torch.bfloat16) * 0.8)(D, ks) * 0.5), 'ssm_k': _w((lambda *s: torch.randn(*s, dtype=torch.bfloat16) * 0.8)(D, S) * (1.0 / S ** 0.5)), 'ssm_D': _w((lambda *s: torch.randn(*s, dtype=torch.bfloat16) * 0.8)(D))}
    _A_in = _A_setup()

    def _B_setup():
        B, S, D, Dff = (1, 2048, 512, 1376)
        return {'x': _w((lambda *s: torch.randn(*s, dtype=torch.bfloat16) * 0.05)(B, S, D)), 'w1': _w((lambda *s: torch.randn(*s, dtype=torch.bfloat16) * 0.05)(D, Dff)), 'w2': _w((lambda *s: torch.randn(*s, dtype=torch.bfloat16) * 0.05)(Dff, D))}
    _B_in = _B_setup()
    return {'A_q': _A_in['q'], 'A_k': _A_in['k'], 'A_v': _A_in['v'], 'A_shift_k': _A_in['shift_k'], 'A_ssm_k': _A_in['ssm_k'], 'A_ssm_D': _A_in['ssm_D'], 'B_x': _B_in['x'], 'B_w1': _B_in['w1'], 'B_w2': _B_in['w2'], 'c': _w((lambda *s: torch.randn(*s, dtype=torch.bfloat16) * 0.2)(1, 512) * 8.0), 'w_mod': _w((lambda *s: torch.randn(*s, dtype=torch.bfloat16) * 0.2)(512, 6 * 512) * 512 ** (-0.5) * 8.0)}

def reference(A_q, A_k, A_v, A_shift_k, A_ssm_k, A_ssm_D, B_x, B_w1, B_w2, c, w_mod):

    def _A_ref(q, k, v, shift_k, ssm_k, ssm_D):
        B, S, D = q.shape
        ks = shift_k.shape[-1]
        k_pad = _pad(k, ((0, 0), (ks - 1, 0), (0, 0)))
        k_shift = torch.zeros_like(k)
        for t in range(ks):
            k_shift = k_shift + k_pad[:, t:t + S, :] * shift_k[:, ks - 1 - t][None, None, :]
        kv = k_shift * v
        L = 2 * S
        kv_pad = _pad(kv, ((0, 0), (0, S), (0, 0)))
        kf_pad = _pad(ssm_k, ((0, 0), (0, S)))
        kv_f = (lambda x, axes=(-2, -1): torch.fft.rfft2(x.float(), dim=axes))(kv_pad[:, None, :, :], axes=(1, 2))
        kf_f = (lambda x, axes=(-2, -1): torch.fft.rfft2(x.float(), dim=axes))(kf_pad[:, None, :], axes=(1, 2))
        kf_f = (lambda x, *d: x.permute(*d))(kf_f, 1, 2, 0)
        y_f = kv_f * kf_f[None, :, :, :]
        y = (lambda x, s, axes=(-2, -1): torch.fft.irfft2(x, s=s, dim=axes).to(torch.bfloat16))(y_f, (1, L), axes=(1, 2))[:, 0, :S, :]
        y = y + kv * ssm_D[None, None, :]
        return q * y

    def _B_ref(x, w1, w2):
        h = torch.einsum('bsd,df->bsf', x, w1)
        zero = torch.zeros_like(h)
        h = torch.maximum(h, zero)
        return torch.einsum('bsf,fd->bsd', h, w2)
    x = A_q
    mod = (_silu(c) @ w_mod).reshape(c.shape[0], 6, 1, -1)
    sa, ca, ga, sb, cb, gb = (mod[:, 0].clone(), mod[:, 1].clone(), mod[:, 2].clone(), mod[:, 3].clone(), mod[:, 4].clone(), mod[:, 5].clone())
    h = _layernorm(x, axis=-1) * (1 + ca) + sa
    x = x + ga * _A_ref(h, A_k, A_v, A_shift_k, A_ssm_k, A_ssm_D)
    h = _layernorm(x, axis=-1) * (1 + cb) + sb
    x = x + gb * _B_ref(h, B_w1, B_w2)
    return x
```

```asm
; @launch grid=(256,1,1) block=(512,1,1) lds=133632
.amdgcn_target "amdgcn-amd-amdhsa--gfx950"
.text
.globl adaLN_cond__ssm_conv_h3__dense_activation_relu__prompt_kernel
.p2align 8
.type adaLN_cond__ssm_conv_h3__dense_activation_relu__prompt_kernel,@function
adaLN_cond__ssm_conv_h3__dense_activation_relu__prompt_kernel:
    s_cmp_ge_u32 s2, 256
    s_cbranch_scc1 .end_1x
    s_getpc_b64 s[64:65]
.cpf_base:
    s_lshr_b32 s66, s2, 3
    s_lshl_b32 s66, s66, 10
    v_and_b32 v250, 63, v0
    v_lshlrev_b32 v250, 4, v250
    v_add_u32 v250, s66, v250
    v_min_u32 v250, .end_1x-.cpf_base-16, v250
    v_cmp_gt_u32 vcc, 64, v0
    s_and_saveexec_b64 s[66:67], vcc
    s_cbranch_execz .cpf_skip
    global_load_dwordx4 v[252:255], v250, s[64:65]
.cpf_skip:
    s_mov_b64 exec, s[66:67]
    s_load_dwordx8 s[4:11], s[0:1], 0
    s_load_dwordx2 s[26:27], s[0:1], 104
    s_load_dwordx4 s[12:15], s[0:1], 32
    s_load_dwordx8 s[16:23], s[0:1], 56
    s_load_dwordx2 s[24:25], s[0:1], 88
    v_and_b32 v1, 63, v0
    v_lshrrev_b32 v2, 6, v0
    s_and_b32 s44, s2, 7
    v_readfirstlane_b32 s46, v2
    s_lshr_b32 s45, s2, 3
    v_lshlrev_b32 v9, 4, v1
    v_and_b32 v6, 15, v1
    v_lshrrev_b32 v7, 4, v1
    v_and_b32 v4, 7, v1
    v_lshrrev_b32 v10, 3, v1
    v_mov_b32 v5, 0
    s_mov_b32 s42, 0x1121000
    s_mov_b32 s43, 0x20000
    s_mov_b32 s60, 17825792
    s_and_b32 s47, s46, 3
    s_and_b32 s48, s45, 7
    s_lshr_b32 s50, s45, 3
    s_lshl_b32 s49, s44, 2
    s_add_u32 s49, s49, s50
    s_lshl_b32 s64, s47, 11
    v_lshlrev_b32 v3, 10, v10
    v_lshl_add_u32 v3, v4, 4, v3
    s_lshl_b32 s67, s44, 6
    s_lshl_b32 s68, s45, 1
    s_add_u32 s57, s67, s68
    s_cmp_ge_u32 s46, 4
    s_cbranch_scc1 .side_2
    s_setprio 2
    s_lshl_b32 s65, s45, 16
    s_lshl_b32 s66, s47, 14
    s_add_u32 s65, s65, s66
    s_lshl_b32 s66, s44, 7
    s_add_u32 s65, s65, s66
    v_add_u32 v3, s65, v3
    s_movk_i32 s66, 0x2000
    v_subrev_u32 v11, s66, v3
    s_lshl_b32 s68, s47, 4
    s_add_u32 s68, s67, s68
    v_add_u32 v8, s68, v4
    v_lshlrev_b32 v16, 3, v8
    s_mov_b32 s30, 0x200000
    s_mov_b32 s31, 0x20000
    s_mov_b32 s34, 0x200000
    s_mov_b32 s35, 0x20000
    s_mov_b32 m0, 58880
    s_waitcnt lgkmcnt(0)
    s_mov_b32 s28, s6
    s_mov_b32 s29, s7
    s_cmp_lg_u32 s46, 0
    s_cbranch_scc1 .nohalo_4
    buffer_load_dwordx4 v11, s[28:31], 0 offen nt lds
.nohalo_4:
    s_add_u32 m0, s64, 59904
    s_mov_b32 s32, s8
    buffer_load_dwordx4 v3, s[28:31], 0 offen nt lds
    s_add_u32 m0, s64, 60928
    s_mov_b32 s33, s9
    buffer_load_dwordx4 v3, s[28:31], s66 offen nt lds
    s_add_u32 m0, s64, 68096
    s_load_dword s62, s[26:27], s60
    buffer_load_dwordx4 v3, s[32:35], 0 offen nt lds
    s_add_u32 m0, s64, 69120
    s_mov_b32 s40, s26
    buffer_load_dwordx4 v3, s[32:35], s66 offen nt lds
    global_load_dwordx2 v[12:13], v16, s[10:11]
    global_load_dwordx2 v[14:15], v16, s[10:11] offset:64
    s_mov_b32 s41, s27
    s_lshl_b32 s60, s57, 1
    s_load_dword s56, s[14:15], s60
    v_lshlrev_b32 v16, 4, v7
    v_bfe_u32 v17, v1, 2, 2
    v_add_u32 v16, v16, v17
    v_bfe_u32 v17, v1, 1, 1
    v_lshl_add_u32 v16, v17, 3, v16
    v_lshlrev_b32 v11, 7, v16
    v_and_b32 v17, 1, v1
    v_lshl_add_u32 v11, v17, 3, v11
    s_lshl_b32 s69, s47, 5
    s_add_u32 s69, s69, 58880
    v_add_u32 v11, s69, v11
    v_lshlrev_b32 v8, 12, v4
    s_lshl_b32 s69, s45, 7
    v_lshl_add_u32 v18, v10, 4, s69
    v_sub_u32 v17, v8, v18
    v_add_u32 v17, 4080, v17
    s_lshl_b32 s58, s44, 2
    s_add_u32 s58, s58, s47
    s_mul_i32 s58, s58, 196608
    s_add_u32 s58, s58, 131072
    s_add_u32 s61, s58, 0x8000
    s_lshr_b32 s68, s47, 1
    s_and_b32 s69, s47, 1
    v_and_b32 v16, 31, v1
    v_lshl_add_u32 v16, v16, 3, s44
    v_lshlrev_b32 v84, 9, v16
    s_lshl_b32 s60, s50, 7
    s_add_u32 s59, s60, 16777216
    s_lshl_b32 s60, s2, 9
    s_lshl_b32 s70, s47, 7
    s_add_u32 s39, s60, s70
    v_add_u32 v76, 1, v6
    v_and_b32 v77, 3, v76
    v_sub_u32 v76, v76, v77
    v_mul_u32_u24 v77, 4160, v77
    v_lshl_add_u32 v2, v76, 1, v77
    v_lshl_add_u32 v2, v7, 4, v2
    s_mul_i32 s60, s68, 16640
    s_lshl_b32 s70, s69, 8
    s_add_u32 s60, s60, s70
    s_add_u32 s60, s60, 16384
    v_add_u32 v2, s60, v2
    v_lshlrev_b32 v76, 5, v6
    v_lshlrev_b32 v77, 4, v7
    v_sub_u32 v3, v77, v76
    s_mul_i32 s71, s68, 4608
    s_add_u32 s60, s71, s70
    s_add_u32 s60, s60, 50144
    v_add_u32 v3, s60, v3
    s_lshl_b32 s37, s48, 1
    s_add_u32 s37, s37, s68
    s_lshl_b32 s37, s37, 12
    s_mul_i32 s70, s49, 196608
    s_add_u32 s37, s37, s70
    s_lshl_b32 s70, s69, 11
    s_add_u32 s37, s37, s70
    s_add_u32 s37, s37, 131072
    s_add_u32 s60, s71, s70
    s_add_u32 m0, s60, 49664
    s_sub_u32 s60, s71, s70
    s_add_u32 s60, s60, 52216
    v_lshl_add_u32 v76, v7, 3, v76
    v_sub_u32 v86, s60, v76
    s_lshl_b32 s60, s47, 12
    s_add_u32 s60, s60, 76288
    v_add_u32 v85, s60, v9
    s_xor_b32 s60, s47, 1
    s_lshl_b32 s60, s60, 12
    s_add_u32 s60, s60, 76288
    v_add_u32 v87, s60, v9
    s_waitcnt lgkmcnt(0)
    s_barrier
    s_add_u32 s62, s62, 1
    s_lshl_b32 s70, s56, 16
    s_and_b32 s71, s56, 0xffff0000
    s_cmp_eq_u32 s68, 0
    s_cselect_b32 s56, s70, s71
    s_add_u32 s70, s39, 16777216
    v_mov_b32 v82, s70
    s_add_u32 s70, s39, 16908288
    v_writelane_b32 v82, s70, 1
    s_lshl_b32 s71, s2, 7
    s_add_u32 s70, s71, 17104896
    v_writelane_b32 v82, s70, 2
    s_add_u32 s70, s71, 17137664
    v_writelane_b32 v82, s70, 3
    s_lshl_b32 s70, s39, 1
    s_add_u32 s70, s70, 17465344
    v_writelane_b32 v82, s70, 4
    s_add_u32 s70, s70, 128
    v_writelane_b32 v82, s70, 5
    s_lshl_b32 s70, s49, 12
    s_lshl_b32 s71, s48, 9
    s_add_u32 s70, s70, s71
    s_lshl_b32 s71, s47, 7
    s_add_u32 s70, s70, s71
    s_add_u32 s70, s70, 17829888
    v_writelane_b32 v82, s70, 6
    buffer_load_dword v250, v82, s[40:43], 0 offen sc1
    s_waitcnt vmcnt(1)
    v_mov_b32 v18, 1
    s_mov_b64 exec, 1
    ds_add_u32 v5, v18 offset:0
    s_mov_b64 exec, -1
    s_mov_b32 s60, 0xffff
    v_alignbit_b32 v20, v12, v12, 16
    v_alignbit_b32 v21, v13, v13, 16
    v_and_b32 v22, 0xffff, v12
    v_bfi_b32 v23, s60, v13, v12
    v_and_b32 v24, 0xffff0000, v13
    v_alignbit_b32 v25, v14, v14, 16
    v_alignbit_b32 v26, v15, v15, 16
    v_and_b32 v27, 0xffff, v14
    v_bfi_b32 v28, s60, v15, v14
    v_and_b32 v29, 0xffff0000, v15
    s_mov_b32 s63, 0
.ss_5:
    ds_read_b32 v18, v5 offset:0
    s_add_u32 s63, s63, 1
    s_cmp_gt_u32 s63, 262144
    s_cbranch_scc1 .ssx_6
    s_waitcnt lgkmcnt(0)
    v_cmp_gt_u32 vcc, 4, v18
    s_cbranch_vccnz .ss_5
.ssx_6:
    ds_read_b64_tr_b16 v[30:31], v11 offset:512
    ds_read_b64_tr_b16 v[32:33], v11 offset:1024
    ds_read_b64_tr_b16 v[34:35], v11 offset:1536
    ds_read_b64_tr_b16 v[36:37], v11 offset:9216
    ds_read_b64_tr_b16 v[38:39], v11 offset:9728
    ds_read_b64_tr_b16 v[44:45], v11 offset:528
    ds_read_b64_tr_b16 v[46:47], v11 offset:1040
    ds_read_b64_tr_b16 v[48:49], v11 offset:1552
    ds_read_b64_tr_b16 v[50:51], v11 offset:9232
    ds_read_b64_tr_b16 v[52:53], v11 offset:9744
    s_waitcnt lgkmcnt(7)
    v_dot2_f32_bf16 v59, v32, v20, 0
    v_dot2_f32_bf16 v58, v32, v22, 0
    v_dot2_f32_bf16 v61, v33, v20, 0
    v_dot2_f32_bf16 v60, v33, v22, 0
    v_dot2_f32_bf16 v63, v34, v20, 0
    v_dot2_f32_bf16 v62, v34, v22, 0
    v_dot2_f32_bf16 v65, v35, v20, 0
    v_dot2_f32_bf16 v64, v35, v22, 0
    v_dot2_f32_bf16 v59, v31, v21, v59
    v_dot2_f32_bf16 v58, v31, v23, v58
    v_dot2_f32_bf16 v61, v32, v21, v61
    v_dot2_f32_bf16 v60, v32, v23, v60
    v_dot2_f32_bf16 v63, v33, v21, v63
    v_dot2_f32_bf16 v62, v33, v23, v62
    v_dot2_f32_bf16 v65, v34, v21, v65
    v_dot2_f32_bf16 v64, v34, v23, v64
    v_dot2_f32_bf16 v58, v30, v24, v58
    v_dot2_f32_bf16 v60, v31, v24, v60
    v_dot2_f32_bf16 v62, v32, v24, v62
    v_dot2_f32_bf16 v64, v33, v24, v64
    s_waitcnt lgkmcnt(5)
    v_lshlrev_b32 v74, 16, v36
    v_and_b32 v75, 0xffff0000, v36
    v_lshlrev_b32 v76, 16, v37
    v_and_b32 v77, 0xffff0000, v37
    v_lshlrev_b32 v78, 16, v38
    v_and_b32 v79, 0xffff0000, v38
    v_lshlrev_b32 v80, 16, v39
    v_and_b32 v81, 0xffff0000, v39
    v_pk_mul_f32 v[58:59], v[58:59], v[74:75]
    v_pk_mul_f32 v[60:61], v[60:61], v[76:77]
    v_pk_mul_f32 v[62:63], v[62:63], v[78:79]
    v_pk_mul_f32 v[64:65], v[64:65], v[80:81]
    v_cvt_pk_bf16_f32 v36, v65, v64
    v_cvt_pk_bf16_f32 v37, v63, v62
    v_cvt_pk_bf16_f32 v38, v61, v60
    v_cvt_pk_bf16_f32 v39, v59, v58
    s_waitcnt lgkmcnt(2)
    v_dot2_f32_bf16 v67, v46, v25, 0
    v_dot2_f32_bf16 v66, v46, v27, 0
    v_dot2_f32_bf16 v69, v47, v25, 0
    v_dot2_f32_bf16 v68, v47, v27, 0
    v_dot2_f32_bf16 v71, v48, v25, 0
    v_dot2_f32_bf16 v70, v48, v27, 0
    v_dot2_f32_bf16 v73, v49, v25, 0
    v_dot2_f32_bf16 v72, v49, v27, 0
    v_dot2_f32_bf16 v67, v45, v26, v67
    v_dot2_f32_bf16 v66, v45, v28, v66
    v_dot2_f32_bf16 v69, v46, v26, v69
    v_dot2_f32_bf16 v68, v46, v28, v68
    v_dot2_f32_bf16 v71, v47, v26, v71
    v_dot2_f32_bf16 v70, v47, v28, v70
    v_dot2_f32_bf16 v73, v48, v26, v73
    v_dot2_f32_bf16 v72, v48, v28, v72
    v_dot2_f32_bf16 v66, v44, v29, v66
    v_dot2_f32_bf16 v68, v45, v29, v68
    v_dot2_f32_bf16 v70, v46, v29, v70
    v_dot2_f32_bf16 v72, v47, v29, v72
    s_waitcnt lgkmcnt(0)
    v_lshlrev_b32 v74, 16, v50
    v_and_b32 v75, 0xffff0000, v50
    v_lshlrev_b32 v76, 16, v51
    v_and_b32 v77, 0xffff0000, v51
    v_lshlrev_b32 v78, 16, v52
    v_and_b32 v79, 0xffff0000, v52
    v_lshlrev_b32 v80, 16, v53
    v_and_b32 v81, 0xffff0000, v53
    v_pk_mul_f32 v[66:67], v[66:67], v[74:75]
    v_pk_mul_f32 v[68:69], v[68:69], v[76:77]
    v_pk_mul_f32 v[70:71], v[70:71], v[78:79]
    v_pk_mul_f32 v[72:73], v[72:73], v[80:81]
    v_cvt_pk_bf16_f32 v50, v73, v72
    v_cvt_pk_bf16_f32 v51, v71, v70
    v_cvt_pk_bf16_f32 v52, v69, v68
    v_cvt_pk_bf16_f32 v53, v67, v66
    buffer_store_dwordx4 v[36:39], v17, s[40:43], s58 offen
    buffer_store_dwordx4 v[50:53], v17, s[40:43], s61 offen
    s_getreg_b32 s38, hwreg(HW_REG_XCC_ID, 0, 4)
    s_lshl_b32 s38, s38, 28
    s_xor_b32 s38, s38, s62
    s_xor_b32 s36, s62, 0x08000000
    v_mov_b32 v18, s38
    s_add_u32 s60, s39, 16777216
    v_mov_b32 v82, 1
    s_mov_b64 exec, 1
    ds_add_u32 v5, v82 offset:64
    s_mov_b64 exec, -1
    s_waitcnt vmcnt(0)
    buffer_store_dword v18, v5, s[40:43], s60 offen
    s_mov_b32 s63, 0
.ss_7:
    ds_read_b32 v82, v5 offset:12
    s_add_u32 s63, s63, 1
    s_cmp_gt_u32 s63, 262144
    s_cbranch_scc1 .ssx_8
    s_waitcnt lgkmcnt(0)
    v_cmp_gt_u32 vcc, 1, v82
    s_cbranch_vccnz .ss_7
.ssx_8:
    v_readfirstlane_b32 s51, v82
    s_lshr_b32 s51, s51, 1
    s_cmp_lg_u32 s51, 0
    s_cbranch_scc1 .fast_9
    v_mov_b32 v18, s36
    buffer_wbl2 sc1
    s_waitcnt vmcnt(0)
    buffer_store_dword v18, v5, s[40:43], s60 offen sc1
.fast_9:
    s_cmp_lg_u32 s46, 0
    s_cbranch_scc1 .np_10
    s_mov_b32 s63, 0
.f1_12:
    buffer_load_dword v18, v84, s[40:43], s59 offen sc1
    s_add_u32 s63, s63, 1
    s_cmp_gt_u32 s63, 262144
    s_cbranch_scc1 .f1x_13
    s_waitcnt vmcnt(0)
    v_cmp_ne_u32 vcc, s38, v18
    v_cmp_ne_u32 s[70:71], s36, v18
    s_and_b64 vcc, vcc, s[70:71]
    s_cbranch_scc0 .f1x_13
    s_sleep 1
    s_branch .f1_12
.f1x_13:
    v_mov_b32 v18, 1
    s_mov_b64 exec, 1
    ds_add_u32 v5, v18 offset:68
    s_mov_b64 exec, -1
    s_branch .pj_11
.np_10:
    s_mov_b32 s63, 0
.ss_14:
    ds_read_b32 v18, v5 offset:68
    s_add_u32 s63, s63, 1
    s_cmp_gt_u32 s63, 262144
    s_cbranch_scc1 .ssx_15
    s_waitcnt lgkmcnt(0)
    v_cmp_gt_u32 vcc, 1, v18
    s_cbranch_vccnz .ss_14
.ssx_15:
.pj_11:
    buffer_load_dwordx4 v9, s[40:43], s37 offen sc1 lds
    buffer_load_dwordx4 v9, s[40:43], s37 offen offset:1024 sc1 lds
    v_mov_b32 v18, 1
    s_mov_b64 exec, 1
    ds_add_u32 v5, v18 offset:8
    s_mov_b64 exec, -1
    s_lshl_b32 s21, s50, 2
    s_mul_i32 s52, s48, 11
    s_cmp_eq_u32 s48, 7
    s_cselect_b32 s20, 1, 0
    s_sub_u32 s52, s52, s20
    s_cmp_ge_u32 s48, 6
    s_cselect_b32 s20, 10, 11
    s_add_u32 s60, s47, 4
    s_add_u32 s61, s60, s52
    s_lshl_b32 s53, s61, 14
    s_add_u32 s53, s53, 6291456
    s_lshl_b32 s58, s61, 10
    s_cmp_lt_u32 s60, s20
    s_cselect_b32 s53, s53, 1073741824
    s_cselect_b32 s58, s58, 1073741824
    v_mov_b32 v12, v85
    v_mov_b32 v13, v86
    v_mov_b32 v14, v87
    s_add_u32 s60, s50, 0
    s_and_b32 s60, s60, 3
    s_lshl_b32 s60, s60, 12
    v_add_u32 v192, s60, v9
    s_add_u32 s60, s50, 1
    s_and_b32 s60, s60, 3
    s_lshl_b32 s60, s60, 12
    v_add_u32 v193, s60, v9
    s_add_u32 s60, s50, 2
    s_and_b32 s60, s60, 3
    s_lshl_b32 s60, s60, 12
    v_add_u32 v194, s60, v9
    s_add_u32 s60, s50, 3
    s_and_b32 s60, s60, 3
    s_lshl_b32 s60, s60, 12
    v_add_u32 v195, s60, v9
    s_waitcnt vmcnt(0)
    v_mov_b32 v18, 1
    s_mov_b64 exec, 1
    ds_add_u32 v5, v18 offset:4
    s_mov_b64 exec, -1
    s_mov_b32 s63, 0
.ss_16:
    ds_read_b32 v18, v5 offset:4
    s_add_u32 s63, s63, 1
    s_cmp_gt_u32 s63, 262144
    s_cbranch_scc1 .ssx_17
    s_waitcnt lgkmcnt(0)
    v_cmp_gt_u32 vcc, 8, v18
    s_cbranch_vccnz .ss_16
.ssx_17:
    ds_read_b64 v[184:185], v13 offset:1536
    ds_read_b64 v[186:187], v13 offset:1024
    ds_read_b64 v[188:189], v13 offset:512
    ds_read_b64 v[190:191], v13 offset:0
    ds_read_b128 v[136:139], v3 offset:3584
    ds_read_b64 v[104:105], v2 offset:0
    ds_read_b64 v[106:107], v2 offset:8
    ds_read_b128 v[140:143], v3 offset:3072
    ds_read_b64 v[108:109], v2 offset:512
    ds_read_b64 v[110:111], v2 offset:520
    ds_read_b128 v[144:147], v3 offset:2560
    ds_read_b64 v[112:113], v2 offset:1024
    ds_read_b64 v[114:115], v2 offset:1032
    ds_read_b128 v[148:151], v3 offset:2048
    ds_read_b64 v[116:117], v2 offset:1536
    ds_read_b64 v[118:119], v2 offset:1544
    ds_read_b128 v[152:155], v3 offset:1536
    ds_read_b64 v[120:121], v2 offset:2048
    ds_read_b64 v[122:123], v2 offset:2056
    s_waitcnt lgkmcnt(12)
    v_mfma_f32_16x16x32_bf16 v[208:211], v[104:107], v[136:139], 0
    ds_read_b128 v[156:159], v3 offset:1024
    s_waitcnt lgkmcnt(10)
    v_mfma_f32_16x16x32_bf16 v[212:215], v[104:107], v[140:143], 0
    ds_read_b64 v[124:125], v2 offset:2560
    v_mfma_f32_16x16x32_bf16 v[212:215], v[108:111], v[136:139], v[212:215]
    ds_read_b64 v[126:127], v2 offset:2568
    v_mfma_f32_16x16x32_bf16 v[216:219], v[108:111], v[140:143], 0
    ds_read_b128 v[160:163], v3 offset:512
    s_waitcnt lgkmcnt(10)
    v_mfma_f32_16x16x32_bf16 v[216:219], v[104:107], v[144:147], v[216:219]
    ds_read_b64 v[128:129], v2 offset:3072
    v_mfma_f32_16x16x32_bf16 v[220:223], v[108:111], v[144:147], 0
    ds_read_b64 v[130:131], v2 offset:3080
    v_mfma_f32_16x16x32_bf16 v[216:219], v[112:115], v[136:139], v[216:219]
    ds_read_b128 v[164:167], v3 offset:0
    v_mfma_f32_16x16x32_bf16 v[220:223], v[112:115], v[140:143], v[220:223]
    ds_read_b64 v[132:133], v2 offset:3584
    v_mfma_f32_16x16x32_bf16 v[224:227], v[112:115], v[144:147], 0
    ds_read_b64 v[134:135], v2 offset:3592
    s_waitcnt lgkmcnt(12)
    v_mfma_f32_16x16x32_bf16 v[220:223], v[104:107], v[148:151], v[220:223]
    ds_read_b128 v[72:75], v3 offset:3648
    v_mfma_f32_16x16x32_bf16 v[224:227], v[108:111], v[148:151], v[224:227]
    ds_read_b64 v[40:41], v2 offset:64
    v_mfma_f32_16x16x32_bf16 v[228:231], v[112:115], v[148:151], 0
    ds_read_b64 v[42:43], v2 offset:72
    v_mfma_f32_16x16x32_bf16 v[220:223], v[116:119], v[136:139], v[220:223]
    ds_read_b128 v[76:79], v3 offset:3136
    v_mfma_f32_16x16x32_bf16 v[224:227], v[116:119], v[140:143], v[224:227]
    ds_read_b64 v[44:45], v2 offset:576
    v_mfma_f32_16x16x32_bf16 v[228:231], v[116:119], v[144:147], v[228:231]
    ds_read_b64 v[46:47], v2 offset:584
    v_mfma_f32_16x16x32_bf16 v[232:235], v[116:119], v[148:151], 0
    ds_read_b128 v[80:83], v3 offset:2624
    s_waitcnt lgkmcnt(15)
    v_mfma_f32_16x16x32_bf16 v[224:227], v[104:107], v[152:155], v[224:227]
    ds_read_b64 v[48:49], v2 offset:1088
    v_mfma_f32_16x16x32_bf16 v[228:231], v[108:111], v[152:155], v[228:231]
    ds_read_b64 v[50:51], v2 offset:1096
    v_mfma_f32_16x16x32_bf16 v[232:235], v[112:115], v[152:155], v[232:235]
    ds_read_b128 v[84:87], v3 offset:2112
    v_mfma_f32_16x16x32_bf16 v[236:239], v[116:119], v[152:155], 0
    ds_read_b64 v[52:53], v2 offset:1600
    v_mfma_f32_16x16x32_bf16 v[224:227], v[120:123], v[136:139], v[224:227]
    ds_read_b64 v[54:55], v2 offset:1608
    v_mfma_f32_16x16x32_bf16 v[228:231], v[120:123], v[140:143], v[228:231]
    ds_read_b128 v[88:91], v3 offset:1600
    v_mfma_f32_16x16x32_bf16 v[232:235], v[120:123], v[144:147], v[232:235]
    ds_read_b64 v[56:57], v2 offset:2112
    v_mfma_f32_16x16x32_bf16 v[236:239], v[120:123], v[148:151], v[236:239]
    ds_read_b64 v[58:59], v2 offset:2120
    s_waitcnt lgkmcnt(15)
    v_mfma_f32_16x16x32_bf16 v[228:231], v[104:107], v[156:159], v[228:231]
    ds_read_b128 v[92:95], v3 offset:1088
    v_mfma_f32_16x16x32_bf16 v[232:235], v[108:111], v[156:159], v[232:235]
    ds_read_b64 v[60:61], v2 offset:2624
    v_mfma_f32_16x16x32_bf16 v[236:239], v[112:115], v[156:159], v[236:239]
    ds_read_b64 v[62:63], v2 offset:2632
    v_mfma_f32_16x16x32_bf16 v[228:231], v[124:127], v[136:139], v[228:231]
    ds_read_b128 v[96:99], v3 offset:576
    v_mfma_f32_16x16x32_bf16 v[232:235], v[124:127], v[140:143], v[232:235]
    ds_read_b64 v[64:65], v2 offset:3136
    v_mfma_f32_16x16x32_bf16 v[236:239], v[124:127], v[144:147], v[236:239]
    ds_read_b64 v[66:67], v2 offset:3144
    s_waitcnt lgkmcnt(15)
    v_mfma_f32_16x16x32_bf16 v[232:235], v[104:107], v[160:163], v[232:235]
    ds_read_b128 v[100:103], v3 offset:64
    v_mfma_f32_16x16x32_bf16 v[236:239], v[108:111], v[160:163], v[236:239]
    ds_read_b64 v[68:69], v2 offset:3648
    v_mfma_f32_16x16x32_bf16 v[232:235], v[128:131], v[136:139], v[232:235]
    ds_read_b64 v[70:71], v2 offset:3656
    v_mfma_f32_16x16x32_bf16 v[236:239], v[128:131], v[140:143], v[236:239]
    s_waitcnt lgkmcnt(15)
    v_mfma_f32_16x16x32_bf16 v[236:239], v[104:107], v[164:167], v[236:239]
    v_mfma_f32_16x16x32_bf16 v[236:239], v[132:135], v[136:139], v[236:239]
    s_waitcnt lgkmcnt(15)
    v_mfma_f32_16x16x32_bf16 v[208:211], v[40:43], v[72:75], v[208:211]
    ds_read_b128 v[136:139], v3 offset:3712
    s_waitcnt lgkmcnt(15)
    v_mfma_f32_16x16x32_bf16 v[212:215], v[40:43], v[76:79], v[212:215]
    ds_read_b64 v[104:105], v2 offset:128
    v_mfma_f32_16x16x32_bf16 v[212:215], v[44:47], v[72:75], v[212:215]
    v_and_b32 v168, 0xffff0000, v185
    v_mfma_f32_16x16x32_bf16 v[216:219], v[44:47], v[76:79], v[216:219]
    ds_read_b64 v[106:107], v2 offset:136
    s_waitcnt lgkmcnt(15)
    v_mfma_f32_16x16x32_bf16 v[216:219], v[40:43], v[80:83], v[216:219]
    ds_read_b128 v[140:143], v3 offset:3200
    v_mfma_f32_16x16x32_bf16 v[220:223], v[44:47], v[80:83], v[220:223]
    v_lshlrev_b32 v169, 16, v185
    v_mfma_f32_16x16x32_bf16 v[216:219], v[48:51], v[72:75], v[216:219]
    ds_read_b64 v[108:109], v2 offset:640
    v_mfma_f32_16x16x32_bf16 v[220:223], v[48:51], v[76:79], v[220:223]
    ds_read_b64 v[110:111], v2 offset:648
    v_mfma_f32_16x16x32_bf16 v[224:227], v[48:51], v[80:83], v[224:227]
    v_and_b32 v170, 0xffff0000, v184
    s_waitcnt lgkmcnt(15)
    v_mfma_f32_16x16x32_bf16 v[220:223], v[40:43], v[84:87], v[220:223]
    ds_read_b128 v[144:147], v3 offset:2688
    v_mfma_f32_16x16x32_bf16 v[224:227], v[44:47], v[84:87], v[224:227]
    ds_read_b64 v[112:113], v2 offset:1152
    v_mfma_f32_16x16x32_bf16 v[228:231], v[48:51], v[84:87], v[228:231]
    v_lshlrev_b32 v171, 16, v184
    v_mfma_f32_16x16x32_bf16 v[220:223], v[52:55], v[72:75], v[220:223]
    ds_read_b64 v[114:115], v2 offset:1160
    v_mfma_f32_16x16x32_bf16 v[224:227], v[52:55], v[76:79], v[224:227]
    ds_read_b128 v[148:151], v3 offset:2176
    v_mfma_f32_16x16x32_bf16 v[228:231], v[52:55], v[80:83], v[228:231]
    v_and_b32 v172, 0xffff0000, v187
    v_mfma_f32_16x16x32_bf16 v[232:235], v[52:55], v[84:87], v[232:235]
    ds_read_b64 v[116:117], v2 offset:1664
    s_waitcnt lgkmcnt(15)
    v_mfma_f32_16x16x32_bf16 v[224:227], v[40:43], v[88:91], v[224:227]
    ds_read_b64 v[118:119], v2 offset:1672
    v_mfma_f32_16x16x32_bf16 v[228:231], v[44:47], v[88:91], v[228:231]
    v_lshlrev_b32 v173, 16, v187
    v_mfma_f32_16x16x32_bf16 v[232:235], v[48:51], v[88:91], v[232:235]
    ds_read_b128 v[152:155], v3 offset:1664
    v_mfma_f32_16x16x32_bf16 v[236:239], v[52:55], v[88:91], v[236:239]
    ds_read_b64 v[120:121], v2 offset:2176
    v_mfma_f32_16x16x32_bf16 v[224:227], v[56:59], v[72:75], v[224:227]
    v_and_b32 v174, 0xffff0000, v186
    v_mfma_f32_16x16x32_bf16 v[228:231], v[56:59], v[76:79], v[228:231]
    ds_read_b64 v[122:123], v2 offset:2184
    v_mfma_f32_16x16x32_bf16 v[232:235], v[56:59], v[80:83], v[232:235]
    ds_read_b128 v[156:159], v3 offset:1152
    v_mfma_f32_16x16x32_bf16 v[236:239], v[56:59], v[84:87], v[236:239]
    v_lshlrev_b32 v175, 16, v186
    s_waitcnt lgkmcnt(15)
    v_mfma_f32_16x16x32_bf16 v[228:231], v[40:43], v[92:95], v[228:231]
    ds_read_b64 v[124:125], v2 offset:2688
    v_mfma_f32_16x16x32_bf16 v[232:235], v[44:47], v[92:95], v[232:235]
    ds_read_b64 v[126:127], v2 offset:2696
    v_mfma_f32_16x16x32_bf16 v[236:239], v[48:51], v[92:95], v[236:239]
    v_and_b32 v176, 0xffff0000, v189
    v_mfma_f32_16x16x32_bf16 v[228:231], v[60:63], v[72:75], v[228:231]
    ds_read_b128 v[160:163], v3 offset:640
    v_mfma_f32_16x16x32_bf16 v[232:235], v[60:63], v[76:79], v[232:235]
    ds_read_b64 v[128:129], v2 offset:3200
    v_mfma_f32_16x16x32_bf16 v[236:239], v[60:63], v[80:83], v[236:239]
    v_lshlrev_b32 v177, 16, v189
    s_waitcnt lgkmcnt(15)
    v_mfma_f32_16x16x32_bf16 v[232:235], v[40:43], v[96:99], v[232:235]
    ds_read_b64 v[130:131], v2 offset:3208
    v_mfma_f32_16x16x32_bf16 v[236:239], v[44:47], v[96:99], v[236:239]
    ds_read_b128 v[164:167], v3 offset:128
    v_mfma_f32_16x16x32_bf16 v[232:235], v[64:67], v[72:75], v[232:235]
    v_and_b32 v178, 0xffff0000, v188
    v_mfma_f32_16x16x32_bf16 v[236:239], v[64:67], v[76:79], v[236:239]
    ds_read_b64 v[132:133], v2 offset:3712
    s_waitcnt lgkmcnt(15)
    v_mfma_f32_16x16x32_bf16 v[236:239], v[40:43], v[100:103], v[236:239]
    ds_read_b64 v[134:135], v2 offset:3720
    v_mfma_f32_16x16x32_bf16 v[236:239], v[68:71], v[72:75], v[236:239]
    v_lshlrev_b32 v179, 16, v188
    s_waitcnt lgkmcnt(15)
    v_mfma_f32_16x16x32_bf16 v[208:211], v[104:107], v[136:139], v[208:211]
    ds_read_b128 v[72:75], v3 offset:3776
    s_waitcnt lgkmcnt(15)
    v_mfma_f32_16x16x32_bf16 v[212:215], v[104:107], v[140:143], v[212:215]
    ds_read_b64 v[40:41], v2 offset:192
    v_mfma_f32_16x16x32_bf16 v[212:215], v[108:111], v[136:139], v[212:215]
    v_and_b32 v180, 0xffff0000, v191
    v_mfma_f32_16x16x32_bf16 v[216:219], v[108:111], v[140:143], v[216:219]
    ds_read_b64 v[42:43], v2 offset:200
    s_waitcnt lgkmcnt(15)
    v_mfma_f32_16x16x32_bf16 v[216:219], v[104:107], v[144:147], v[216:219]
    ds_read_b128 v[76:79], v3 offset:3264
    v_mfma_f32_16x16x32_bf16 v[220:223], v[108:111], v[144:147], v[220:223]
    v_lshlrev_b32 v181, 16, v191
    v_mfma_f32_16x16x32_bf16 v[216:219], v[112:115], v[136:139], v[216:219]
    ds_read_b64 v[44:45], v2 offset:704
    v_mfma_f32_16x16x32_bf16 v[220:223], v[112:115], v[140:143], v[220:223]
    ds_read_b64 v[46:47], v2 offset:712
    v_mfma_f32_16x16x32_bf16 v[224:227], v[112:115], v[144:147], v[224:227]
    v_and_b32 v182, 0xffff0000, v190
    s_waitcnt lgkmcnt(15)
    v_mfma_f32_16x16x32_bf16 v[220:223], v[104:107], v[148:151], v[220:223]
    ds_read_b128 v[80:83], v3 offset:2752
    v_mfma_f32_16x16x32_bf16 v[224:227], v[108:111], v[148:151], v[224:227]
    ds_read_b64 v[48:49], v2 offset:1216
    v_mfma_f32_16x16x32_bf16 v[228:231], v[112:115], v[148:151], v[228:231]
    v_lshlrev_b32 v183, 16, v190
    v_mfma_f32_16x16x32_bf16 v[220:223], v[116:119], v[136:139], v[220:223]
    ds_read_b64 v[50:51], v2 offset:1224
    v_mfma_f32_16x16x32_bf16 v[224:227], v[116:119], v[140:143], v[224:227]
    ds_read_b128 v[84:87], v3 offset:2240
    v_mfma_f32_16x16x32_bf16 v[228:231], v[116:119], v[144:147], v[228:231]
    v_mul_f32 v168, s56, v168
    v_mfma_f32_16x16x32_bf16 v[232:235], v[116:119], v[148:151], v[232:235]
    ds_read_b64 v[52:53], v2 offset:1728
    s_waitcnt lgkmcnt(15)
    v_mfma_f32_16x16x32_bf16 v[224:227], v[104:107], v[152:155], v[224:227]
    ds_read_b64 v[54:55], v2 offset:1736
    v_mfma_f32_16x16x32_bf16 v[228:231], v[108:111], v[152:155], v[228:231]
    v_mul_f32 v169, s56, v169
    v_mfma_f32_16x16x32_bf16 v[232:235], v[112:115], v[152:155], v[232:235]
    ds_read_b128 v[88:91], v3 offset:1728
    v_mfma_f32_16x16x32_bf16 v[236:239], v[116:119], v[152:155], v[236:239]
    ds_read_b64 v[56:57], v2 offset:2240
    v_mfma_f32_16x16x32_bf16 v[224:227], v[120:123], v[136:139], v[224:227]
    v_mul_f32 v170, s56, v170
    v_mfma_f32_16x16x32_bf16 v[228:231], v[120:123], v[140:143], v[228:231]
    ds_read_b64 v[58:59], v2 offset:2248
    v_mfma_f32_16x16x32_bf16 v[232:235], v[120:123], v[144:147], v[232:235]
    ds_read_b128 v[92:95], v3 offset:1216
    v_mfma_f32_16x16x32_bf16 v[236:239], v[120:123], v[148:151], v[236:239]
    v_mul_f32 v171, s56, v171
    s_waitcnt lgkmcnt(15)
    v_mfma_f32_16x16x32_bf16 v[228:231], v[104:107], v[156:159], v[228:231]
    ds_read_b64 v[60:61], v2 offset:2752
    v_mfma_f32_16x16x32_bf16 v[232:235], v[108:111], v[156:159], v[232:235]
    ds_read_b64 v[62:63], v2 offset:2760
    v_mfma_f32_16x16x32_bf16 v[236:239], v[112:115], v[156:159], v[236:239]
    v_mul_f32 v172, s56, v172
    v_mfma_f32_16x16x32_bf16 v[228:231], v[124:127], v[136:139], v[228:231]
    ds_read_b128 v[96:99], v3 offset:704
    v_mfma_f32_16x16x32_bf16 v[232:235], v[124:127], v[140:143], v[232:235]
    ds_read_b64 v[64:65], v2 offset:3264
    v_mfma_f32_16x16x32_bf16 v[236:239], v[124:127], v[144:147], v[236:239]
    v_mul_f32 v173, s56, v173
    s_waitcnt lgkmcnt(15)
    v_mfma_f32_16x16x32_bf16 v[232:235], v[104:107], v[160:163], v[232:235]
    ds_read_b64 v[66:67], v2 offset:3272
    v_mfma_f32_16x16x32_bf16 v[236:239], v[108:111], v[160:163], v[236:239]
    ds_read_b128 v[100:103], v3 offset:192
    v_mfma_f32_16x16x32_bf16 v[232:235], v[128:131], v[136:139], v[232:235]
    v_mul_f32 v174, s56, v174
    v_mfma_f32_16x16x32_bf16 v[236:239], v[128:131], v[140:143], v[236:239]
    ds_read_b64 v[68:69], v2 offset:3776
    s_waitcnt lgkmcnt(15)
    v_mfma_f32_16x16x32_bf16 v[236:239], v[104:107], v[164:167], v[236:239]
    ds_read_b64 v[70:71], v2 offset:3784
    v_mfma_f32_16x16x32_bf16 v[236:239], v[132:135], v[136:139], v[236:239]
    v_mul_f32 v175, s56, v175
    s_waitcnt lgkmcnt(15)
    v_mfma_f32_16x16x32_bf16 v[208:211], v[40:43], v[72:75], v[208:211]
    v_mul_f32 v176, s56, v176
    v_mul_f32 v177, s56, v177
    s_waitcnt lgkmcnt(15)
    v_mfma_f32_16x16x32_bf16 v[212:215], v[40:43], v[76:79], v[212:215]
    v_mul_f32 v178, s56, v178
    v_mul_f32 v179, s56, v179
    v_mfma_f32_16x16x32_bf16 v[212:215], v[44:47], v[72:75], v[212:215]
    v_mul_f32 v180, s56, v180
    v_mul_f32 v181, s56, v181
    v_mfma_f32_16x16x32_bf16 v[216:219], v[44:47], v[76:79], v[216:219]
    v_mul_f32 v182, s56, v182
    v_mul_f32 v183, s56, v183
    s_waitcnt lgkmcnt(15)
    v_mfma_f32_16x16x32_bf16 v[216:219], v[40:43], v[80:83], v[216:219]
    v_and_b32 v20, 1, v7
    v_lshlrev_b32 v20, 2, v20
    v_mfma_f32_16x16x32_bf16 v[220:223], v[44:47], v[80:83], v[220:223]
    v_lshrrev_b32 v21, 2, v6
    v_add_u32 v20, v20, v21
    v_mfma_f32_16x16x32_bf16 v[216:219], v[48:51], v[72:75], v[216:219]
    v_mul_u32_u24 v20, 196608, v20
    v_and_b32 v21, 3, v6
    v_mfma_f32_16x16x32_bf16 v[220:223], v[48:51], v[76:79], v[220:223]
    v_lshl_add_u32 v20, v21, 5, v20
    v_and_b32 v21, 2, v7
    v_mfma_f32_16x16x32_bf16 v[224:227], v[48:51], v[80:83], v[224:227]
    v_lshl_add_u32 v20, v21, 3, v20
    s_add_u32 s37, s57, s68
    s_waitcnt lgkmcnt(12)
    v_mfma_f32_16x16x32_bf16 v[220:223], v[40:43], v[84:87], v[220:223]
    s_lshl_b32 s37, s37, 7
    s_mul_i32 s60, s69, 3145728
    v_mfma_f32_16x16x32_bf16 v[224:227], v[44:47], v[84:87], v[224:227]
    s_add_u32 s37, s37, s60
    s_add_u32 s36, s37, 1572864
    v_mfma_f32_16x16x32_bf16 v[228:231], v[48:51], v[84:87], v[228:231]
    s_add_u32 s39, s39, 16908288
    s_lshl_b32 s60, s68, 2
    v_mfma_f32_16x16x32_bf16 v[220:223], v[52:55], v[72:75], v[220:223]
    v_mov_b32 v22, s60
    v_mov_b32 v18, s62
    v_mfma_f32_16x16x32_bf16 v[224:227], v[52:55], v[76:79], v[224:227]
    v_mfma_f32_16x16x32_bf16 v[228:231], v[52:55], v[80:83], v[228:231]
    v_mfma_f32_16x16x32_bf16 v[232:235], v[52:55], v[84:87], v[232:235]
    s_waitcnt lgkmcnt(9)
    v_mfma_f32_16x16x32_bf16 v[224:227], v[40:43], v[88:91], v[224:227]
    v_mfma_f32_16x16x32_bf16 v[228:231], v[44:47], v[88:91], v[228:231]
    v_mfma_f32_16x16x32_bf16 v[232:235], v[48:51], v[88:91], v[232:235]
    v_mfma_f32_16x16x32_bf16 v[236:239], v[52:55], v[88:91], v[236:239]
    v_mfma_f32_16x16x32_bf16 v[224:227], v[56:59], v[72:75], v[224:227]
    v_mfma_f32_16x16x32_bf16 v[228:231], v[56:59], v[76:79], v[228:231]
    v_mfma_f32_16x16x32_bf16 v[232:235], v[56:59], v[80:83], v[232:235]
    v_mfma_f32_16x16x32_bf16 v[236:239], v[56:59], v[84:87], v[236:239]
    s_waitcnt lgkmcnt(6)
    v_mfma_f32_16x16x32_bf16 v[228:231], v[40:43], v[92:95], v[228:231]
    v_mfma_f32_16x16x32_bf16 v[232:235], v[44:47], v[92:95], v[232:235]
    v_mfma_f32_16x16x32_bf16 v[236:239], v[48:51], v[92:95], v[236:239]
    v_mfma_f32_16x16x32_bf16 v[228:231], v[60:63], v[72:75], v[228:231]
    v_mfma_f32_16x16x32_bf16 v[232:235], v[60:63], v[76:79], v[232:235]
    v_mfma_f32_16x16x32_bf16 v[236:239], v[60:63], v[80:83], v[236:239]
    s_waitcnt lgkmcnt(3)
    v_mfma_f32_16x16x32_bf16 v[232:235], v[40:43], v[96:99], v[232:235]
    v_mfma_f32_16x16x32_bf16 v[236:239], v[44:47], v[96:99], v[236:239]
    v_mfma_f32_16x16x32_bf16 v[232:235], v[64:67], v[72:75], v[232:235]
    v_mfma_f32_16x16x32_bf16 v[236:239], v[64:67], v[76:79], v[236:239]
    s_waitcnt lgkmcnt(0)
    v_mfma_f32_16x16x32_bf16 v[236:239], v[40:43], v[100:103], v[236:239]
    v_mfma_f32_16x16x32_bf16 v[236:239], v[68:71], v[72:75], v[236:239]
    s_cmp_eq_u32 s69, 0
    s_cbranch_scc0 .xa_18
    ds_write_b128 v12, v[224:227]
    v_pk_add_f32 v[168:169], v[168:169], v[208:209]
    v_pk_add_f32 v[170:171], v[170:171], v[210:211]
    v_pk_add_f32 v[172:173], v[172:173], v[212:213]
    v_pk_add_f32 v[174:175], v[174:175], v[214:215]
    v_pk_add_f32 v[176:177], v[176:177], v[216:217]
    v_pk_add_f32 v[178:179], v[178:179], v[218:219]
    v_pk_add_f32 v[180:181], v[180:181], v[220:221]
    v_pk_add_f32 v[182:183], v[182:183], v[222:223]
    ds_write_b128 v12, v[228:231] offset:1024
    ds_write_b128 v12, v[232:235] offset:2048
    ds_write_b128 v12, v[236:239] offset:3072
    s_branch .xb_19
.xa_18:
    ds_write_b128 v12, v[208:211] offset:0
    ds_write_b128 v12, v[212:215] offset:1024
    ds_write_b128 v12, v[216:219] offset:2048
    ds_write_b128 v12, v[220:223] offset:3072
    s_nop 1
    v_pk_add_f32 v[168:169], v[168:169], v[224:225]
    v_pk_add_f32 v[170:171], v[170:171], v[226:227]
    v_pk_add_f32 v[172:173], v[172:173], v[228:229]
    v_pk_add_f32 v[174:175], v[174:175], v[230:231]
    v_pk_add_f32 v[176:177], v[176:177], v[232:233]
    v_pk_add_f32 v[178:179], v[178:179], v[234:235]
    v_pk_add_f32 v[180:181], v[180:181], v[236:237]
    v_pk_add_f32 v[182:183], v[182:183], v[238:239]
.xb_19:
    v_mov_b32 v23, 1
    s_waitcnt lgkmcnt(0)
    s_mov_b64 exec, 1
    ds_add_u32 v22, v23 offset:16
    s_mov_b64 exec, -1
    s_mov_b32 s63, 0
.ss_20:
    ds_read_b32 v23, v22 offset:16
    s_add_u32 s63, s63, 1
    s_cmp_gt_u32 s63, 262144
    s_cbranch_scc1 .ssx_21
    s_waitcnt lgkmcnt(0)
    v_cmp_gt_u32 vcc, 2, v23
    s_cbranch_vccnz .ss_20
.ssx_21:
    ds_read_b128 v[24:27], v14 offset:0
    ds_read_b128 v[28:31], v14 offset:1024
    ds_read_b128 v[32:35], v14 offset:2048
    ds_read_b128 v[36:39], v14 offset:3072
    s_waitcnt lgkmcnt(3)
    v_pk_add_f32 v[168:169], v[168:169], v[24:25]
    v_pk_add_f32 v[170:171], v[170:171], v[26:27]
    v_cvt_pk_bf16_f32 v40, v168, v169
    v_cvt_pk_bf16_f32 v41, v170, v171
    s_waitcnt lgkmcnt(2)
    v_pk_add_f32 v[172:173], v[172:173], v[28:29]
    v_pk_add_f32 v[174:175], v[174:175], v[30:31]
    v_cvt_pk_bf16_f32 v42, v172, v173
    v_cvt_pk_bf16_f32 v43, v174, v175
    s_nop 1
    v_permlane16_swap_b32 v40, v42
    v_permlane16_swap_b32 v41, v43
    buffer_store_dwordx4 v[40:43], v20, s[40:43], s37 offen sc1
    s_waitcnt lgkmcnt(1)
    v_pk_add_f32 v[176:177], v[176:177], v[32:33]
    v_pk_add_f32 v[178:179], v[178:179], v[34:35]
    v_cvt_pk_bf16_f32 v44, v176, v177
    v_cvt_pk_bf16_f32 v45, v178, v179
    s_waitcnt lgkmcnt(0)
    v_pk_add_f32 v[180:181], v[180:181], v[36:37]
    v_pk_add_f32 v[182:183], v[182:183], v[38:39]
    v_cvt_pk_bf16_f32 v46, v180, v181
    v_cvt_pk_bf16_f32 v47, v182, v183
    s_nop 1
    v_permlane16_swap_b32 v44, v46
    v_permlane16_swap_b32 v45, v47
    buffer_store_dwordx4 v[44:47], v20, s[40:43], s36 offen sc1
    s_setprio 0
    s_mul_i32 s22, s50, 5
    s_mul_i32 s60, s48, 3
    s_add_u32 s22, s22, s60
    s_sub_u32 s60, s22, 22
    s_cmp_ge_u32 s22, 22
    s_cselect_b32 s22, s60, s22
    s_lshl_b32 s22, s22, 12
    s_cmp_ge_u32 s47, 2
    s_cselect_b32 s31, 1073741824, 86016
    s_cmp_eq_u32 s22, 86016
    s_cselect_b32 s78, s31, s22
    s_cselect_b32 s22, 4294963200, s22
    s_add_u32 s22, s22, 4096
    s_cmp_eq_u32 s22, 86016
    s_cselect_b32 s79, s31, s22
    s_cselect_b32 s22, 4294963200, s22
    s_add_u32 s22, s22, 4096
    s_cmp_eq_u32 s22, 86016
    s_cselect_b32 s80, s31, s22
    s_cselect_b32 s22, 4294963200, s22
    s_add_u32 s22, s22, 4096
    s_cmp_eq_u32 s22, 86016
    s_cselect_b32 s81, s31, s22
    s_cselect_b32 s22, 4294963200, s22
    s_add_u32 s22, s22, 4096
    s_cmp_eq_u32 s22, 86016
    s_cselect_b32 s82, s31, s22
    s_cselect_b32 s22, 4294963200, s22
    s_add_u32 s22, s22, 4096
    s_cmp_eq_u32 s22, 86016
    s_cselect_b32 s83, s31, s22
    s_cselect_b32 s22, 4294963200, s22
    s_add_u32 s22, s22, 4096
    s_cmp_eq_u32 s22, 86016
    s_cselect_b32 s84, s31, s22
    s_cselect_b32 s22, 4294963200, s22
    s_add_u32 s22, s22, 4096
    s_cmp_eq_u32 s22, 86016
    s_cselect_b32 s85, s31, s22
    s_cselect_b32 s22, 4294963200, s22
    s_add_u32 s22, s22, 4096
    s_cmp_eq_u32 s22, 86016
    s_cselect_b32 s86, s31, s22
    s_cselect_b32 s22, 4294963200, s22
    s_add_u32 s22, s22, 4096
    s_cmp_eq_u32 s22, 86016
    s_cselect_b32 s87, s31, s22
    s_cselect_b32 s22, 4294963200, s22
    s_add_u32 s22, s22, 4096
    s_cmp_eq_u32 s22, 86016
    s_cselect_b32 s88, s31, s22
    s_cselect_b32 s22, 4294963200, s22
    s_add_u32 s22, s22, 4096
    s_cmp_eq_u32 s22, 86016
    s_cselect_b32 s89, s31, s22
    s_cselect_b32 s22, 4294963200, s22
    s_add_u32 s22, s22, 4096
    s_cmp_eq_u32 s22, 86016
    s_cselect_b32 s90, s31, s22
    s_cselect_b32 s22, 4294963200, s22
    s_add_u32 s22, s22, 4096
    s_cmp_eq_u32 s22, 86016
    s_cselect_b32 s91, s31, s22
    s_cselect_b32 s22, 4294963200, s22
    s_add_u32 s22, s22, 4096
    s_cmp_eq_u32 s22, 86016
    s_cselect_b32 s92, s31, s22
    s_cselect_b32 s22, 4294963200, s22
    s_add_u32 s22, s22, 4096
    s_cmp_eq_u32 s22, 86016
    s_cselect_b32 s93, s31, s22
    s_cselect_b32 s22, 4294963200, s22
    s_add_u32 s22, s22, 4096
    s_cmp_eq_u32 s22, 86016
    s_cselect_b32 s94, s31, s22
    s_cselect_b32 s22, 4294963200, s22
    s_add_u32 s22, s22, 4096
    s_cmp_eq_u32 s22, 86016
    s_cselect_b32 s95, s31, s22
    s_cselect_b32 s22, 4294963200, s22
    s_add_u32 s22, s22, 4096
    s_cmp_eq_u32 s22, 86016
    s_cselect_b32 s96, s31, s22
    s_cselect_b32 s22, 4294963200, s22
    s_add_u32 s22, s22, 4096
    s_cmp_eq_u32 s22, 86016
    s_cselect_b32 s97, s31, s22
    s_cselect_b32 s22, 4294963200, s22
    s_add_u32 s22, s22, 4096
    s_cmp_eq_u32 s22, 86016
    s_cselect_b32 s98, s31, s22
    s_cselect_b32 s22, 4294963200, s22
    s_add_u32 s22, s22, 4096
    s_cmp_eq_u32 s22, 86016
    s_cselect_b32 s99, s31, s22
    s_cselect_b32 s22, 4294963200, s22
    s_add_u32 s22, s22, 4096
    s_lshr_b32 s33, s46, 2
    s_lshl_b32 s27, s48, 1
    s_add_u32 s27, s27, s33
    s_xor_b32 s61, s27, 1
    s_mul_i32 s27, s27, 88064
    s_mul_i32 s61, s61, 88064
    s_lshl_b32 s60, s47, 10
    s_add_u32 s60, s60, 8388608
    s_add_u32 s27, s27, s60
    s_add_u32 s61, s61, s60
    s_and_b32 s60, s46, 1
    s_lshl_b32 s60, s60, 8
    v_xor_b32 v15, s60, v9
    v_add_u32 v36, s61, v15
    v_add_u32 v15, s27, v15
    v_lshlrev_b32 v20, 13, v7
    v_lshl_add_u32 v20, v6, 4, v20
    s_and_b32 s64, s2, 0xc7
    s_lshl_b32 s64, s64, 10
    s_lshl_b32 s60, s47, 8
    s_add_u32 s64, s64, s60
    s_add_u32 s64, s64, 17203200
    s_add_u32 s65, s64, 0x8000
    v_lshrrev_b32 v21, 1, v7
    v_and_b32 v21, v21, v7
    v_add_u32 v21, v21, v7
    v_lshlrev_b32 v21, 12, v21
    v_lshl_add_u32 v21, v6, 3, v21
    v_mul_u32_u24 v22, 24576, v7
    v_lshl_add_u32 v22, v6, 3, v22
    s_lshl_b32 s66, s48, 9
    s_lshl_b32 s60, s47, 7
    s_add_u32 s66, s66, s60
    s_add_u32 s66, s66, 17727488
    s_add_u32 s67, s66, 24576
    s_add_u32 s68, s66, 49152
    s_add_u32 s69, s66, 73728
    s_add_u32 s70, s66, 20480
    s_add_u32 s71, s66, 12288
    v_min_u32 v23, 42, v1
    v_lshlrev_b32 v23, 9, v23
    s_lshr_b32 s57, s48, 1
    s_lshl_b32 s57, s57, 7
    s_add_u32 s57, s57, 17072128
    s_cmp_eq_u32 s47, 0
    s_cselect_b32 s57, s57, 1073741824
    v_mov_b32 v90, v23
    v_and_b32 v13, 3, v1
    v_lshrrev_b32 v11, 5, v1
    v_lshl_add_u32 v12, v11, 2, v13
    s_lshl_b32 s60, s46, 3
    v_add_u32 v12, s60, v12
    v_bfe_u32 v16, v1, 2, 3
    v_lshlrev_b32 v18, 7, v12
    v_lshl_add_u32 v18, v16, 4, v18
    s_mul_i32 s29, s49, 196608
    s_lshl_b32 s60, s48, 13
    s_add_u32 s28, s29, s60
    s_add_u32 s29, s29, 65536
    s_add_u32 s30, s29, s60
    s_lshl_b32 s60, s33, 12
    s_add_u32 s30, s30, s60
    s_lshl_b32 s60, s47, 8
    s_add_u32 s30, s30, s60
    s_lshl_b32 s60, s46, 3
    v_add_u32 v19, s60, v4
    v_lshrrev_b32 v2, 1, v19
    v_lshlrev_b32 v2, 12, v2
    v_and_b32 v19, 1, v1
    v_lshl_add_u32 v19, v19, 8, v2
    s_lshl_b32 s32, s48, 9
    s_lshr_b32 s60, s49, 4
    s_lshl_b32 s60, s60, 7
    s_add_u32 s32, s32, s60
    s_add_u32 s32, s32, 16908288
    v_and_b32 v2, 1, v7
    v_lshl_add_u32 v2, v2, 2, v13
    v_lshlrev_b32 v2, 3, v2
    v_bfe_u32 v3, v1, 2, 2
    v_add_u32 v2, v2, v3
    v_lshlrev_b32 v2, 7, v2
    v_lshl_add_u32 v2, v11, 3, v2
    s_lshl_b32 s60, s46, 4
    s_add_u32 s60, s60, 109056
    v_add_u32 v2, s60, v2
    v_lshlrev_b32 v10, 7, v3
    v_lshl_add_u32 v10, v7, 5, v10
    v_lshl_add_u32 v10, v13, 3, v10
    s_lshl_b32 s60, s46, 10
    s_add_u32 s60, s60, 58880
    v_add_u32 v10, s60, v10
    v_lshlrev_b32 v37, 10, v7
    v_lshl_add_u32 v37, v6, 4, v37
    v_lshlrev_b32 v3, 5, v16
    v_lshlrev_b32 v12, 5, v12
    s_lshl_b32 s34, s2, 7
    s_and_b32 s36, s2, 0xc7
    s_lshl_b32 s36, s36, 7
    s_lshl_b32 s38, s49, 12
    s_lshl_b32 s60, s46, 9
    s_add_u32 s38, s38, s60
    s_add_u32 s38, s38, 17829888
    v_lshlrev_b32 v8, 10, v4
    v_mov_b32 v39, s62
    s_lshl_b32 s60, s47, 10
    s_add_u32 s29, s29, s60
    s_lshl_b32 s61, s33, 12
    s_add_u32 s52, s60, s61
    s_add_u32 s37, s36, 17104896
    s_add_u32 s60, s50, 0
    s_and_b32 s60, s60, 3
    s_lshl_b32 s60, s60, 14
    s_add_u32 s4, s60, s29
    s_add_u32 s60, s50, 1
    s_and_b32 s60, s60, 3
    s_lshl_b32 s60, s60, 14
    s_add_u32 s5, s60, s29
    s_add_u32 s60, s50, 2
    s_and_b32 s60, s60, 3
    s_lshl_b32 s60, s60, 14
    s_add_u32 s6, s60, s29
    s_add_u32 s60, s50, 3
    s_and_b32 s60, s60, 3
    s_lshl_b32 s60, s60, 14
    s_add_u32 s7, s60, s29
    s_waitcnt vmcnt(0)
    buffer_store_dword v39, v5, s[40:43], s39 offen sc1
    buffer_load_dwordx4 v[40:43], v20, s[40:43], s64 offen sc1
    buffer_load_dwordx4 v[44:47], v20, s[40:43], s65 offen sc1
    buffer_load_dwordx2 v[48:49], v21, s[40:43], s66 offen sc1
    buffer_load_dwordx2 v[50:51], v21, s[40:43], s67 offen sc1
    buffer_load_dwordx2 v[52:53], v21, s[40:43], s68 offen sc1
    buffer_load_dwordx2 v[54:55], v21, s[40:43], s69 offen sc1
    buffer_load_dwordx2 v[56:57], v22, s[40:43], s70 offen sc1
    buffer_load_dwordx2 v[58:59], v22, s[40:43], s71 offen sc1
    s_mov_b32 s63, 0
.ss_25:
    ds_read_b32 v24, v5 offset:32
    s_add_u32 s63, s63, 1
    s_cmp_gt_u32 s63, 262144
    s_cbranch_scc1 .ssx_26
    s_waitcnt lgkmcnt(0)
    v_cmp_gt_u32 vcc, 1, v24
    s_cbranch_vccnz .ss_25
.ssx_26:
    buffer_load_dwordx4 v[164:167], v192, s[40:43], s53 offen offset:0 sc1
    buffer_load_dwordx4 v[160:163], v192, s[40:43], s53 offen offset:1024 sc1
    buffer_load_dwordx4 v[156:159], v193, s[40:43], s53 offen offset:0 sc1
    buffer_load_dwordx4 v[152:155], v194, s[40:43], s53 offen offset:0 sc1
    buffer_load_dwordx4 v[148:151], v195, s[40:43], s53 offen offset:0 sc1
    buffer_load_dwordx4 v[144:147], v192, s[40:43], s53 offen offset:2048 sc1
    buffer_load_dwordx4 v[140:143], v193, s[40:43], s53 offen offset:1024 sc1
    buffer_load_dwordx4 v[136:139], v194, s[40:43], s53 offen offset:1024 sc1
    s_mov_b32 s63, 0
    s_waitcnt vmcnt(8)
    s_branch .tg0_24
.tg_22:
    s_sleep 2
    buffer_load_dwordx4 v[40:43], v20, s[40:43], s64 offen sc1
    buffer_load_dwordx4 v[44:47], v20, s[40:43], s65 offen sc1
    buffer_load_dwordx2 v[48:49], v21, s[40:43], s66 offen sc1
    buffer_load_dwordx2 v[50:51], v21, s[40:43], s67 offen sc1
    buffer_load_dwordx2 v[52:53], v21, s[40:43], s68 offen sc1
    buffer_load_dwordx2 v[54:55], v21, s[40:43], s69 offen sc1
    buffer_load_dwordx2 v[56:57], v22, s[40:43], s70 offen sc1
    buffer_load_dwordx2 v[58:59], v22, s[40:43], s71 offen sc1
    s_add_u32 s63, s63, 1
    s_cmp_gt_u32 s63, 262144
    s_cbranch_scc1 .tgx_23
    s_waitcnt vmcnt(0)
.tg0_24:
    v_xor_b32 v24, s62, v42
    v_bitop3_b32 v24, v24, v46, s62 bitop3:0xf6
    v_bitop3_b32 v24, v24, v49, s62 bitop3:0xf6
    v_bitop3_b32 v24, v24, v51, s62 bitop3:0xf6
    v_bitop3_b32 v24, v24, v53, s62 bitop3:0xf6
    v_bitop3_b32 v24, v24, v55, s62 bitop3:0xf6
    v_bitop3_b32 v24, v24, v57, s62 bitop3:0xf6
    v_bitop3_b32 v24, v24, v59, s62 bitop3:0xf6
    v_cmp_ne_u32 vcc, 0, v24
    s_cbranch_vccnz .tg_22
.tgx_23:
    v_add_f32 v48, v48, v50
    v_add_f32 v52, v52, v54
    v_mov_b32 v57, v56
    v_mov_b32 v59, v58
    v_add_f32 v48, v48, v52
    s_lshl_b32 s60, s47, 9
    v_permlane32_swap_b32 v56, v57
    v_permlane32_swap_b32 v58, v59
    v_lshlrev_b32 v24, 5, v6
    v_add_f32 v56, v56, v57
    v_add_f32 v58, v58, v59
    v_mov_b32 v57, v56
    v_mov_b32 v59, v58
    v_lshl_add_u32 v24, v7, 2, v24
    v_add_u32 v24, s60, v24
    v_permlane16_swap_b32 v56, v57
    v_permlane16_swap_b32 v58, v59
    s_lshl_b32 s60, s47, 6
    v_lshl_add_u32 v25, v6, 2, s60
    v_add_f32 v56, v56, v57
    v_add_f32 v58, v58, v59
    v_cvt_pk_bf16_f32 v48, v48, v56
    v_lshlrev_b32 v49, 16, v48
    v_and_b32 v52, 0xffff0000, v48
    ds_write_b32 v24, v49 offset:1408
    ds_write_b32 v25, v52 offset:1152
    v_add_f32 v49, 1.0, v49
    v_cvt_pk_bf16_f32 v58, v49, v58
    v_mov_b32 v59, s62
    v_lshlrev_b32 v26, 3, v6
    s_lshl_b32 s60, s49, 12
    s_lshl_b32 s61, s48, 9
    s_add_u32 s60, s60, s61
    s_lshl_b32 s61, s47, 7
    s_add_u32 s60, s60, s61
    s_add_u32 s60, s60, 17829888
    s_mov_b32 exec_lo, 0
    s_mov_b32 exec_hi, 0xffff0000
    s_cmp_eq_u32 s51, 0
    s_cbranch_scc1 .slow_27
    buffer_store_dwordx2 v[58:59], v26, s[40:43], s60 offen
    s_branch .pubd_28
.slow_27:
    buffer_store_dwordx2 v[58:59], v26, s[40:43], s60 offen sc1
.pubd_28:
    s_mov_b64 exec, -1
    v_pk_add_f32 v[40:41], v[40:41], v[44:45]
    s_nop 0
    v_mov_b32 v44, v40
    v_mov_b32 v45, v41
    s_nop 1
    v_permlane32_swap_b32 v40, v44
    v_permlane32_swap_b32 v41, v45
    v_pk_add_f32 v[40:41], v[40:41], v[44:45]
    s_nop 0
    v_mov_b32 v44, v40
    v_mov_b32 v45, v41
    s_nop 1
    v_permlane16_swap_b32 v40, v44
    v_permlane16_swap_b32 v41, v45
    v_add_f32 v40, v40, v44
    v_add_f32 v41, v41, v45
    v_mul_f32 v40, 0x3b000000, v40
    v_mul_f32 v41, 0x3b000000, v41
    v_fma_f32 v41, -v40, v40, v41
    v_max_f32 v41, 0, v41
    v_cvt_pk_bf16_f32 v44, v41, v40
    v_lshlrev_b32 v41, 16, v44
    v_and_b32 v40, 0xffff0000, v44
    v_add_f32 v41, 0x3727c5ac, v41
    v_cvt_pk_bf16_f32 v41, v41, v41
    v_and_b32 v41, 0xffff0000, v41
    v_sqrt_f32 v41, v41
    s_nop 0
    v_cvt_pk_bf16_f32 v41, v41, v41
    v_and_b32 v41, 0xffff0000, v41
    v_rcp_f32 v41, v41
    s_nop 0
    ds_write_b32 v25, v40 offset:128
    ds_write_b32 v25, v41 offset:384
    s_waitcnt lgkmcnt(0)
    v_mov_b32 v24, 1
    s_mov_b64 exec, 1
    ds_add_u32 v5, v24 offset:44
    s_mov_b64 exec, -1
    buffer_load_dwordx4 v[132:135], v195, s[40:43], s53 offen offset:1024 sc1
    buffer_load_dwordx4 v[128:131], v192, s[40:43], s53 offen offset:3072 sc1
    buffer_load_dwordx4 v[104:107], v193, s[40:43], s53 offen offset:2048 sc1
    buffer_load_dwordx4 v[108:111], v194, s[40:43], s53 offen offset:2048 sc1
    buffer_load_dwordx4 v[112:115], v195, s[40:43], s53 offen offset:2048 sc1
    buffer_load_dwordx4 v[116:119], v193, s[40:43], s53 offen offset:3072 sc1
    buffer_load_dwordx4 v[120:123], v194, s[40:43], s53 offen offset:3072 sc1
    buffer_load_dwordx4 v[124:127], v195, s[40:43], s53 offen offset:3072 sc1
    s_add_u32 s8, s4, 0
    s_add_u32 s9, s5, 0
    s_add_u32 s10, s7, 0
    s_add_u32 s11, s5, 4096
    s_add_u32 s12, s7, 4096
    s_add_u32 s13, s5, 8192
    s_add_u32 s14, s7, 8192
    s_add_u32 s15, s6, 12288
    s_mov_b32 s63, 0
.ss_29:
    ds_read_b32 v88, v5 offset:44
    s_add_u32 s63, s63, 1
    s_cmp_gt_u32 s63, 262144
    s_cbranch_scc1 .ssx_30
    s_waitcnt lgkmcnt(0)
    v_cmp_gt_u32 vcc, 4, v88
    s_sleep 1
    s_cbranch_vccnz .ss_29
.ssx_30:
    v_lshlrev_b32 v92, 3, v1
    buffer_load_dword v88, v19, s[40:43], s32 offen sc1
    buffer_load_dwordx2 v[94:95], v92, s[40:43], s38 offen sc1
    ds_read_b64_tr_b16 v[56:57], v2
    ds_read_b64_tr_b16 v[58:59], v2 offset:512
    ds_read_b128 v[60:63], v12 offset:1408
    ds_read_b128 v[64:67], v3 offset:128
    ds_read_b128 v[68:71], v3 offset:144
    ds_read_b128 v[72:75], v3 offset:384
    ds_read_b128 v[76:79], v3 offset:400
    ds_read_b32 v91, v5 offset:12
    s_lshl_b32 s60, s46, 7
    v_lshl_add_u32 v93, v1, 1, s60
    s_add_u32 s35, s34, 17104896
    s_waitcnt lgkmcnt(5)
    v_lshlrev_b32 v40, 16, v56
    v_and_b32 v41, 0xffff0000, v56
    v_lshlrev_b32 v42, 16, v57
    v_and_b32 v43, 0xffff0000, v57
    v_lshlrev_b32 v44, 16, v58
    v_and_b32 v45, 0xffff0000, v58
    v_lshlrev_b32 v46, 16, v59
    v_and_b32 v47, 0xffff0000, v59
    v_add_f32 v61, 1.0, v61
    v_add_f32 v63, 1.0, v63
    v_cvt_pk_bf16_f32 v56, v61, v63
    v_lshlrev_b32 v61, 16, v56
    v_and_b32 v82, 0xffff0000, v56
    v_mul_f32 v80, v62, v61
    v_mul_f32 v81, v62, v60
    s_waitcnt lgkmcnt(0)
    v_readfirstlane_b32 s51, v91
    s_lshr_b32 s51, s51, 1
    s_lshl_b32 s60, s51, 26
    s_xor_b32 s60, s60, s62
    v_mov_b32 v17, s60
    v_pk_add_f32 v[48:49], v[40:41], v[64:65] neg_lo:[0,1] neg_hi:[0,1]
    v_pk_add_f32 v[50:51], v[42:43], v[66:67] neg_lo:[0,1] neg_hi:[0,1]
    v_pk_add_f32 v[52:53], v[44:45], v[68:69] neg_lo:[0,1] neg_hi:[0,1]
    v_pk_add_f32 v[54:55], v[46:47], v[70:71] neg_lo:[0,1] neg_hi:[0,1]
    v_pk_mul_f32 v[72:73], v[72:73], v[80:81] op_sel_hi:[1,0]
    v_pk_mul_f32 v[74:75], v[74:75], v[80:81] op_sel_hi:[1,0]
    v_pk_mul_f32 v[76:77], v[76:77], v[80:81] op_sel_hi:[1,0]
    v_pk_mul_f32 v[78:79], v[78:79], v[80:81] op_sel_hi:[1,0]
    v_pk_fma_f32 v[48:49], v[48:49], v[72:73], v[80:81] op_sel:[0,0,1] op_sel_hi:[1,1,1]
    v_pk_fma_f32 v[50:51], v[50:51], v[74:75], v[80:81] op_sel:[0,0,1] op_sel_hi:[1,1,1]
    v_pk_fma_f32 v[52:53], v[52:53], v[76:77], v[80:81] op_sel:[0,0,1] op_sel_hi:[1,1,1]
    v_pk_fma_f32 v[54:55], v[54:55], v[78:79], v[80:81] op_sel:[0,0,1] op_sel_hi:[1,1,1]
    s_waitcnt vmcnt(0)
    v_cmp_ne_u32 vcc, s62, v88
    s_cbranch_vccz .f4ok_31
    s_mov_b32 s63, 0
.poll_32:
    buffer_load_dword v88, v19, s[40:43], s32 offen sc1
    s_add_u32 s63, s63, 1
    s_cmp_gt_u32 s63, 262144
    s_cbranch_scc1 .pollx_33
    s_waitcnt vmcnt(0)
    v_cmp_ne_u32 vcc, s62, v88
    s_cbranch_vccz .pollx_33
    s_sleep 2
    s_branch .poll_32
.pollx_33:
.f4ok_31:
    buffer_load_dwordx4 v[56:59], v18, s[40:43], s28 offen sc1
    v_cmp_ne_u32 vcc, s62, v95
    s_cbranch_vccz .a2ok_34
    s_mov_b32 s63, 0
.poll_35:
    buffer_load_dwordx2 v[94:95], v92, s[40:43], s38 offen sc1
    s_add_u32 s63, s63, 1
    s_cmp_gt_u32 s63, 262144
    s_cbranch_scc1 .pollx_36
    s_waitcnt vmcnt(0)
    v_cmp_ne_u32 vcc, s62, v95
    s_cbranch_vccz .pollx_36
    s_sleep 1
    s_branch .poll_35
.pollx_36:
.a2ok_34:
    ds_write_b16 v93, v94 offset:3712
    ds_write_b16 v93, v94 offset:4736
    ds_write_b16_d16_hi v93, v94 offset:5824
    ds_write_b16_d16_hi v93, v94 offset:6848
    s_waitcnt vmcnt(0)
    v_lshlrev_b32 v60, 16, v56
    v_and_b32 v61, 0xffff0000, v56
    v_lshlrev_b32 v62, 16, v57
    v_and_b32 v63, 0xffff0000, v57
    v_lshlrev_b32 v64, 16, v58
    v_and_b32 v65, 0xffff0000, v58
    v_lshlrev_b32 v66, 16, v59
    v_and_b32 v67, 0xffff0000, v59
    v_pk_fma_f32 v[40:41], v[48:49], v[60:61], v[40:41]
    v_pk_fma_f32 v[42:43], v[50:51], v[62:63], v[42:43]
    v_pk_fma_f32 v[44:45], v[52:53], v[64:65], v[44:45]
    v_pk_fma_f32 v[46:47], v[54:55], v[66:67], v[46:47]
    v_pk_mul_f32 v[60:61], v[40:41], v[82:83] op_sel_hi:[1,0]
    v_pk_mul_f32 v[62:63], v[42:43], v[82:83] op_sel_hi:[1,0]
    v_pk_mul_f32 v[64:65], v[44:45], v[82:83] op_sel_hi:[1,0]
    v_pk_mul_f32 v[66:67], v[46:47], v[82:83] op_sel_hi:[1,0]
    v_cvt_pk_bf16_f32 v68, v60, v61
    v_cvt_pk_bf16_f32 v69, v62, v63
    v_cvt_pk_bf16_f32 v70, v64, v65
    v_cvt_pk_bf16_f32 v71, v66, v67
    ds_write_b128 v18, v[68:71] offset:58880
    ds_read_b64_tr_b16 v[72:73], v10
    ds_read_b64_tr_b16 v[74:75], v10 offset:512
    v_cvt_pk_bf16_f32 v56, v40, v41
    v_cvt_pk_bf16_f32 v57, v42, v43
    v_cvt_pk_bf16_f32 v58, v44, v45
    v_cvt_pk_bf16_f32 v59, v46, v47
    ds_write_b128 v18, v[56:59] offset:8192
    s_waitcnt lgkmcnt(1)
    buffer_store_dwordx4 v[72:75], v37, s[40:43], s30 offen
    v_and_b32 v2, 1, v1
    v_mul_u32_u24 v2, 2112, v2
    v_lshl_add_u32 v2, v7, 4, v2
    s_lshl_b32 s60, s50, 8
    v_add_u32 v2, s60, v2
    s_lshl_b32 s60, s47, 10
    v_add_u32 v3, 16384, v9
    s_waitcnt vmcnt(0) lgkmcnt(0)
    v_mov_b32 v88, 1
    s_mov_b64 exec, 1
    ds_add_rtn_u32 v88, v5, v88 offset:48
    s_mov_b64 exec, -1
    s_waitcnt lgkmcnt(0)
    v_readfirstlane_b32 s63, v88
    s_cmp_eq_u32 s63, 7
    s_cselect_b32 s35, s35, 1073741824
    s_cmp_eq_u32 s51, 0
    s_cbranch_scc1 .slow_37
    buffer_store_dword v17, v5, s[40:43], s35 offen
    s_branch .pubd_38
.slow_37:
    buffer_wbl2 sc1
    s_waitcnt vmcnt(0)
    buffer_store_dword v17, v5, s[40:43], s35 offen sc1
.pubd_38:
    s_xor_b32 s61, s60, 0
    v_add_u32 v10, s61, v3
    s_xor_b32 s61, s60, 1024
    v_add_u32 v18, s61, v3
    s_xor_b32 s61, s60, 2048
    v_add_u32 v19, s61, v3
    s_xor_b32 s61, s60, 3072
    v_add_u32 v37, s61, v3
    s_mov_b32 s63, 0
.ss_39:
    ds_read_b32 v88, v5 offset:48
    s_add_u32 s63, s63, 1
    s_cmp_gt_u32 s63, 262144
    s_cbranch_scc1 .ssx_40
    s_waitcnt lgkmcnt(0)
    v_cmp_gt_u32 vcc, 8, v88
    s_cbranch_vccnz .ss_39
.ssx_40:
    buffer_load_dword v88, v8, s[40:43], s37 offen sc1
    ds_read_b128 v[56:59], v2 offset:3712
    ds_read_b128 v[60:63], v2 offset:3776
    ds_read_b128 v[64:67], v2 offset:3968
    ds_read_b128 v[68:71], v2 offset:4224
    s_waitcnt lgkmcnt(3)
    v_mfma_f32_16x16x32_bf16 v[28:31], v[164:167], v[56:59], 0
    ds_read_b128 v[56:59], v2 offset:4480
    s_waitcnt lgkmcnt(3)
    v_mfma_f32_16x16x32_bf16 v[28:31], v[160:163], v[60:63], v[28:31]
    ds_read_b128 v[60:63], v2 offset:3840
    s_waitcnt lgkmcnt(3)
    v_mfma_f32_16x16x32_bf16 v[28:31], v[156:159], v[64:67], v[28:31]
    ds_read_b128 v[64:67], v2 offset:4032
    s_waitcnt lgkmcnt(3)
    v_mfma_f32_16x16x32_bf16 v[28:31], v[152:155], v[68:71], v[28:31]
    ds_read_b128 v[68:71], v2 offset:4288
    s_waitcnt lgkmcnt(3)
    v_mfma_f32_16x16x32_bf16 v[28:31], v[148:151], v[56:59], v[28:31]
    ds_read_b128 v[56:59], v2 offset:4544
    s_waitcnt lgkmcnt(3)
    v_mfma_f32_16x16x32_bf16 v[28:31], v[144:147], v[60:63], v[28:31]
    ds_read_b128 v[60:63], v2 offset:3904
    s_waitcnt lgkmcnt(3)
    v_mfma_f32_16x16x32_bf16 v[28:31], v[140:143], v[64:67], v[28:31]
    ds_read_b128 v[64:67], v2 offset:4096
    s_waitcnt lgkmcnt(3)
    v_mfma_f32_16x16x32_bf16 v[28:31], v[136:139], v[68:71], v[28:31]
    ds_read_b128 v[68:71], v2 offset:4352
    s_waitcnt lgkmcnt(3)
    v_mfma_f32_16x16x32_bf16 v[28:31], v[132:135], v[56:59], v[28:31]
    ds_read_b128 v[56:59], v2 offset:4608
    s_waitcnt lgkmcnt(3)
    v_mfma_f32_16x16x32_bf16 v[28:31], v[128:131], v[60:63], v[28:31]
    ds_read_b128 v[60:63], v2 offset:4160
    s_waitcnt lgkmcnt(3)
    v_mfma_f32_16x16x32_bf16 v[28:31], v[104:107], v[64:67], v[28:31]
    ds_read_b128 v[64:67], v2 offset:4416
    s_waitcnt lgkmcnt(3)
    v_mfma_f32_16x16x32_bf16 v[28:31], v[108:111], v[68:71], v[28:31]
    ds_read_b128 v[68:71], v2 offset:4672
    s_waitcnt lgkmcnt(3)
    v_mfma_f32_16x16x32_bf16 v[28:31], v[112:115], v[56:59], v[28:31]
    s_waitcnt lgkmcnt(2)
    v_mfma_f32_16x16x32_bf16 v[28:31], v[116:119], v[60:63], v[28:31]
    s_waitcnt lgkmcnt(1)
    v_mfma_f32_16x16x32_bf16 v[28:31], v[120:123], v[64:67], v[28:31]
    s_waitcnt lgkmcnt(0)
    v_mfma_f32_16x16x32_bf16 v[28:31], v[124:127], v[68:71], v[28:31]
    s_mov_b32 s63, 0
    s_mov_b32 s60, 0xfbffffff
.f6_41:
    s_waitcnt vmcnt(0)
    v_xor_b32 v88, s62, v88
    v_and_b32 v89, s60, v88
    v_cmp_ne_u32 vcc, 0, v89
    s_cbranch_vccz .f6x_42
    s_add_u32 s63, s63, 1
    s_cmp_gt_u32 s63, 262144
    s_cbranch_scc1 .f6x_42
    s_sleep 1
    buffer_load_dword v88, v8, s[40:43], s37 offen sc1
    s_branch .f6_41
.f6x_42:
    s_add_u32 m0, s52, 16384
    s_nop 0
    buffer_load_dwordx4 v9, s[40:43], s8 offen sc1 lds
    s_add_u32 m0, s52, 24576
    s_nop 0
    buffer_load_dwordx4 v9, s[40:43], s9 offen sc1 lds
    s_mov_b32 s66, 0x55555555
    s_mov_b32 s67, 0x55555555
    v_mov_b32_dpp v62, v28 quad_perm:[1,0,3,2] row_mask:0xf bank_mask:0xf
    v_mov_b32_dpp v63, v29 quad_perm:[1,0,3,2] row_mask:0xf bank_mask:0xf
    v_mov_b32_dpp v64, v30 quad_perm:[1,0,3,2] row_mask:0xf bank_mask:0xf
    v_mov_b32_dpp v65, v31 quad_perm:[1,0,3,2] row_mask:0xf bank_mask:0xf
    v_cndmask_b32 v20, v62, v28, s[66:67]
    v_cndmask_b32 v28, v28, v62, s[66:67]
    v_cndmask_b32 v21, v63, v29, s[66:67]
    v_cndmask_b32 v29, v29, v63, s[66:67]
    v_cndmask_b32 v22, v64, v30, s[66:67]
    v_cndmask_b32 v30, v30, v64, s[66:67]
    v_cndmask_b32 v23, v65, v31, s[66:67]
    v_cndmask_b32 v31, v31, v65, s[66:67]
    s_and_b32 s30, s46, 1
    s_bfe_u32 s35, s46, 0x10001
    v_lshrrev_b32 v16, 5, v1
    v_bfe_u32 v11, v1, 2, 2
    v_lshl_add_u32 v11, v16, 2, v11
    v_lshlrev_b32 v11, 7, v11
    v_lshl_add_u32 v11, v13, 3, v11
    v_bfe_u32 v12, v1, 4, 1
    v_lshl_add_u32 v11, v12, 5, v11
    s_lshl_b32 s60, s33, 12
    s_lshl_b32 s61, s30, 11
    s_add_u32 s60, s60, s61
    s_lshl_b32 s61, s35, 6
    s_add_u32 s60, s60, s61
    v_add_u32 v11, s60, v11
    ds_read_b64_tr_b16 v[248:249], v11 offset:8192
    ds_read_b64_tr_b16 v[250:251], v11 offset:9216
    s_lshl_b32 s60, s33, 7
    s_lshl_b32 s61, s30, 6
    s_add_u32 s60, s60, s61
    v_lshl_add_u32 v12, v16, 4, s60
    ds_read_b128 v[240:243], v12 offset:1152
    ds_read_b128 v[244:247], v12 offset:1184
    v_and_b32 v17, 31, v1
    v_lshlrev_b32 v17, 10, v17
    v_lshl_add_u32 v17, v16, 4, v17
    s_lshl_b32 s32, s49, 16
    s_lshl_b32 s61, s35, 15
    s_add_u32 s32, s32, s61
    s_lshl_b32 s61, s48, 7
    s_add_u32 s32, s32, s61
    s_lshl_b32 s61, s33, 6
    s_add_u32 s32, s32, s61
    s_lshl_b32 s61, s30, 5
    s_add_u32 s32, s32, s61
    v_cmp_eq_u32 vcc, 0, v88
    s_mul_i32 s60, s49, 176128
    s_add_u32 s60, s60, 10485760
    s_mul_i32 s61, s49, 196608
    s_cmp_eq_u64 vcc, 0
    s_cselect_b32 s60, s61, s60
    s_mul_i32 s18, s35, 88064
    s_sub_u32 s19, 88064, s18
    s_add_u32 s18, s18, s60
    s_add_u32 s19, s19, s60
    s_lshl_b32 s60, s30, 8
    v_xor_b32 v38, s60, v9
    s_lshl_b32 s60, s47, 10
    s_add_u32 s61, s60, s18
    v_add_u32 v11, s61, v9
    s_add_u32 s61, s60, s19
    v_add_u32 v12, s61, v9
    s_add_u32 s28, s34, 17137664
    s_add_u32 s29, s36, 17137664
    v_lshlrev_b32 v16, 3, v6
    s_lshl_b32 s60, s47, 7
    v_xor_b32 v16, s60, v16
    s_waitcnt lgkmcnt(2)
    v_lshlrev_b32 v232, 16, v248
    v_and_b32 v233, 0xffff0000, v248
    v_lshlrev_b32 v234, 16, v249
    v_and_b32 v235, 0xffff0000, v249
    v_lshlrev_b32 v236, 16, v250
    v_and_b32 v237, 0xffff0000, v250
    v_lshlrev_b32 v238, 16, v251
    v_and_b32 v239, 0xffff0000, v251
    s_xor_b32 s60, s46, 0
    s_mul_i32 s60, s60, 14336
    s_add_u32 s60, s60, 16384
    v_add_u32 v248, s60, v9
    s_xor_b32 s60, s46, 1
    s_mul_i32 s60, s60, 14336
    s_add_u32 s60, s60, 16384
    v_add_u32 v249, s60, v9
    s_xor_b32 s60, s46, 2
    s_mul_i32 s60, s60, 14336
    s_add_u32 s60, s60, 16384
    v_add_u32 v250, s60, v9
    s_xor_b32 s60, s46, 3
    s_mul_i32 s60, s60, 14336
    s_add_u32 s60, s60, 16384
    v_add_u32 v251, s60, v9
    s_xor_b32 s60, s46, 4
    s_mul_i32 s60, s60, 14336
    s_add_u32 s60, s60, 16384
    v_add_u32 v252, s60, v9
    s_xor_b32 s60, s46, 5
    s_mul_i32 s60, s60, 14336
    s_add_u32 s60, s60, 16384
    v_add_u32 v253, s60, v9
    s_xor_b32 s60, s46, 6
    s_mul_i32 s60, s60, 14336
    s_add_u32 s60, s60, 16384
    v_add_u32 v254, s60, v9
    s_xor_b32 s60, s46, 7
    s_mul_i32 s60, s60, 14336
    s_add_u32 s60, s60, 16384
    v_add_u32 v255, s60, v9
    v_lshlrev_b32 v24, 13, v7
    v_lshl_add_u32 v24, v6, 4, v24
    s_lshl_b32 s64, s36, 3
    s_lshl_b32 s60, s47, 8
    s_add_u32 s64, s64, s60
    s_add_u32 s16, s64, 17465344
    s_add_u32 s17, s16, 0x8000
    v_bfe_u32 v25, v1, 2, 2
    v_lshl_add_u32 v25, v7, 3, v25
    v_lshlrev_b32 v25, 7, v25
    v_lshl_add_u32 v25, v13, 3, v25
    s_lshl_b32 s60, s47, 5
    v_add_u32 v25, s60, v25
    s_or_b32 s60, s2, s46
    s_cmp_eq_u32 s60, 0
    s_cselect_b32 s60, 17825792, 1073741824
    buffer_store_dword v39, v5, s[40:43], s60 offen
    s_add_u32 m0, s52, 32768
    s_nop 0
    buffer_load_dwordx4 v9, s[40:43], s10 offen sc1 lds
    s_add_u32 m0, s52, 40960
    s_nop 0
    buffer_load_dwordx4 v9, s[40:43], s11 offen sc1 lds
    s_waitcnt vmcnt(3)
    s_barrier
    ds_read_b128 v[40:43], v10 offset:0
    ds_read_b128 v[44:47], v18 offset:0
    ds_read_b128 v[48:51], v19 offset:0
    ds_read_b128 v[52:55], v37 offset:0
    s_waitcnt lgkmcnt(3)
    v_mfma_f32_16x16x32_bf16 v[72:75], v[164:167], v[40:43], 0
    ds_read_b128 v[56:59], v10 offset:4096
    s_add_u32 m0, s52, 49152
    s_nop 0
    buffer_load_dwordx4 v9, s[40:43], s12 offen sc1 lds
    s_waitcnt lgkmcnt(3)
    v_mfma_f32_16x16x32_bf16 v[76:79], v[164:167], v[44:47], 0
    ds_read_b128 v[60:63], v18 offset:4096
    s_add_u32 m0, s52, 57344
    s_nop 0
    buffer_load_dwordx4 v9, s[40:43], s13 offen sc1 lds
    s_waitcnt lgkmcnt(3)
    v_mfma_f32_16x16x32_bf16 v[80:83], v[164:167], v[48:51], 0
    ds_read_b128 v[64:67], v19 offset:4096
    s_waitcnt lgkmcnt(3)
    v_mfma_f32_16x16x32_bf16 v[84:87], v[164:167], v[52:55], 0
    ds_read_b128 v[68:71], v37 offset:4096
    s_waitcnt lgkmcnt(3)
    v_mfma_f32_16x16x32_bf16 v[72:75], v[160:163], v[56:59], v[72:75]
    ds_read_b128 v[40:43], v10 offset:8192
    s_add_u32 m0, s52, 65536
    s_nop 0
    buffer_load_dwordx4 v9, s[40:43], s14 offen sc1 lds
    s_waitcnt lgkmcnt(3)
    v_mfma_f32_16x16x32_bf16 v[76:79], v[160:163], v[60:63], v[76:79]
    ds_read_b128 v[44:47], v18 offset:8192
    s_add_u32 m0, s52, 73728
    s_nop 0
    buffer_load_dwordx4 v9, s[40:43], s15 offen sc1 lds
    s_waitcnt lgkmcnt(3)
    v_mfma_f32_16x16x32_bf16 v[80:83], v[160:163], v[64:67], v[80:83]
    ds_read_b128 v[48:51], v19 offset:8192
    s_waitcnt lgkmcnt(3)
    v_mfma_f32_16x16x32_bf16 v[84:87], v[160:163], v[68:71], v[84:87]
    ds_read_b128 v[52:55], v37 offset:8192
    s_waitcnt lgkmcnt(3)
    v_mfma_f32_16x16x32_bf16 v[72:75], v[156:159], v[40:43], v[72:75]
    ds_read_b128 v[56:59], v10 offset:12288
    buffer_load_dwordx4 v[224:227], v15, s[40:43], s78 offen sc1
    s_waitcnt lgkmcnt(3)
    v_mfma_f32_16x16x32_bf16 v[76:79], v[156:159], v[44:47], v[76:79]
    ds_read_b128 v[60:63], v18 offset:12288
    buffer_load_dwordx4 v[228:231], v36, s[40:43], s78 offen sc1
    s_waitcnt lgkmcnt(3)
    v_mfma_f32_16x16x32_bf16 v[80:83], v[156:159], v[48:51], v[80:83]
    ds_read_b128 v[64:67], v19 offset:12288
    s_waitcnt lgkmcnt(3)
    v_mfma_f32_16x16x32_bf16 v[84:87], v[156:159], v[52:55], v[84:87]
    ds_read_b128 v[68:71], v37 offset:12288
    s_waitcnt vmcnt(6)
    s_barrier
    s_waitcnt lgkmcnt(3)
    v_mfma_f32_16x16x32_bf16 v[72:75], v[152:155], v[56:59], v[72:75]
    ds_read_b128 v[40:43], v10 offset:16384
    buffer_load_dwordx4 v[216:219], v15, s[40:43], s79 offen sc1
    s_waitcnt lgkmcnt(3)
    v_mfma_f32_16x16x32_bf16 v[76:79], v[152:155], v[60:63], v[76:79]
    ds_read_b128 v[44:47], v18 offset:16384
    buffer_load_dwordx4 v[220:223], v36, s[40:43], s79 offen sc1
    s_waitcnt lgkmcnt(3)
    v_mfma_f32_16x16x32_bf16 v[80:83], v[152:155], v[64:67], v[80:83]
    ds_read_b128 v[48:51], v19 offset:16384
    s_waitcnt lgkmcnt(3)
    v_mfma_f32_16x16x32_bf16 v[84:87], v[152:155], v[68:71], v[84:87]
    ds_read_b128 v[52:55], v37 offset:16384
    s_waitcnt lgkmcnt(3)
    v_mfma_f32_16x16x32_bf16 v[72:75], v[148:151], v[40:43], v[72:75]
    ds_read_b128 v[56:59], v10 offset:20480
    buffer_load_dwordx4 v[208:211], v15, s[40:43], s80 offen sc1
    s_waitcnt lgkmcnt(3)
    v_mfma_f32_16x16x32_bf16 v[76:79], v[148:151], v[44:47], v[76:79]
    ds_read_b128 v[60:63], v18 offset:20480
    buffer_load_dwordx4 v[212:215], v36, s[40:43], s80 offen sc1
    s_waitcnt lgkmcnt(3)
    v_mfma_f32_16x16x32_bf16 v[80:83], v[148:151], v[48:51], v[80:83]
    ds_read_b128 v[64:67], v19 offset:20480
    s_waitcnt lgkmcnt(3)
    v_mfma_f32_16x16x32_bf16 v[84:87], v[148:151], v[52:55], v[84:87]
    ds_read_b128 v[68:71], v37 offset:20480
    s_waitcnt vmcnt(6)
    s_barrier
    s_waitcnt lgkmcnt(3)
    v_mfma_f32_16x16x32_bf16 v[72:75], v[144:147], v[56:59], v[72:75]
    ds_read_b128 v[40:43], v10 offset:24576
    buffer_load_dwordx4 v[200:203], v15, s[40:43], s81 offen sc1
    s_waitcnt lgkmcnt(3)
    v_mfma_f32_16x16x32_bf16 v[76:79], v[144:147], v[60:63], v[76:79]
    ds_read_b128 v[44:47], v18 offset:24576
    buffer_load_dwordx4 v[204:207], v36, s[40:43], s81 offen sc1
    s_waitcnt lgkmcnt(3)
    v_mfma_f32_16x16x32_bf16 v[80:83], v[144:147], v[64:67], v[80:83]
    ds_read_b128 v[48:51], v19 offset:24576
    s_waitcnt lgkmcnt(3)
    v_mfma_f32_16x16x32_bf16 v[84:87], v[144:147], v[68:71], v[84:87]
    ds_read_b128 v[52:55], v37 offset:24576
    s_waitcnt lgkmcnt(3)
    v_mfma_f32_16x16x32_bf16 v[72:75], v[140:143], v[40:43], v[72:75]
    ds_read_b128 v[56:59], v10 offset:28672
    buffer_load_dwordx4 v[192:195], v15, s[40:43], s82 offen sc1
    s_waitcnt lgkmcnt(3)
    v_mfma_f32_16x16x32_bf16 v[76:79], v[140:143], v[44:47], v[76:79]
    ds_read_b128 v[60:63], v18 offset:28672
    buffer_load_dwordx4 v[196:199], v36, s[40:43], s82 offen sc1
    s_waitcnt lgkmcnt(3)
    v_mfma_f32_16x16x32_bf16 v[80:83], v[140:143], v[48:51], v[80:83]
    ds_read_b128 v[64:67], v19 offset:28672
    s_waitcnt lgkmcnt(3)
    v_mfma_f32_16x16x32_bf16 v[84:87], v[140:143], v[52:55], v[84:87]
    ds_read_b128 v[68:71], v37 offset:28672
    ds_read_b64_tr_b16 v[88:89], v25 offset:8192
    ds_read_b64_tr_b16 v[90:91], v25 offset:8704
    ds_read_b64_tr_b16 v[92:93], v25 offset:12288
    ds_read_b64_tr_b16 v[94:95], v25 offset:12800
    s_mov_b32 s60, 0x3f803f80
    v_mov_b32 v32, s60
    v_mov_b32 v33, s60
    v_mov_b32 v34, s60
    v_mov_b32 v35, s60
    v_and_b32 v14, 3, v1
    v_cmp_eq_u32 s[64:65], 1, v14
    v_cmp_eq_u32 s[66:67], 2, v14
    v_cmp_eq_u32 s[68:69], 3, v14
    v_bfe_u32 v14, v1, 2, 2
    v_cmp_eq_u32 s[70:71], v14, v7
    s_waitcnt lgkmcnt(0)
    v_mfma_f32_16x16x32_bf16 v[96:99], v[88:91], v[88:91], 0
    v_mfma_f32_16x16x32_bf16 v[100:103], v[32:35], v[88:91], 0
    v_mfma_f32_16x16x32_bf16 v[96:99], v[92:95], v[92:95], v[96:99]
    v_mfma_f32_16x16x32_bf16 v[100:103], v[32:35], v[92:95], v[100:103]
    s_lshl_b32 s60, s2, 10
    s_lshl_b32 s61, s47, 8
    s_add_u32 s60, s60, s61
    s_add_u32 s60, s60, 17465344
    v_lshlrev_b32 v14, 4, v6
    s_nop 1
    v_cndmask_b32 v96, v96, v97, s[64:65]
    v_cndmask_b32 v96, v96, v98, s[66:67]
    v_cndmask_b32 v101, v96, v99, s[68:69]
    v_mov_b32 v102, s62
    v_mov_b32 v103, s62
    s_mov_b64 exec, s[70:71]
    s_cmp_eq_u32 s51, 0
    s_cbranch_scc1 .slow_43
    buffer_store_dwordx4 v[100:103], v14, s[40:43], s60 offen
    s_branch .pubd_44
.slow_43:
    buffer_store_dwordx4 v[100:103], v14, s[40:43], s60 offen sc1
.pubd_44:
    s_mov_b64 exec, -1
    s_waitcnt lgkmcnt(3)
    v_mfma_f32_16x16x32_bf16 v[72:75], v[136:139], v[56:59], v[72:75]
    ds_read_b128 v[40:43], v10 offset:32768
    buffer_load_dwordx4 v[184:187], v15, s[40:43], s83 offen sc1
    s_waitcnt lgkmcnt(3)
    v_mfma_f32_16x16x32_bf16 v[76:79], v[136:139], v[60:63], v[76:79]
    ds_read_b128 v[44:47], v18 offset:32768
    buffer_load_dwordx4 v[188:191], v36, s[40:43], s83 offen sc1
    s_waitcnt lgkmcnt(3)
    v_mfma_f32_16x16x32_bf16 v[80:83], v[136:139], v[64:67], v[80:83]
    ds_read_b128 v[48:51], v19 offset:32768
    s_waitcnt lgkmcnt(3)
    v_mfma_f32_16x16x32_bf16 v[84:87], v[136:139], v[68:71], v[84:87]
    ds_read_b128 v[52:55], v37 offset:32768
    s_waitcnt lgkmcnt(3)
    v_mfma_f32_16x16x32_bf16 v[72:75], v[132:135], v[40:43], v[72:75]
    ds_read_b128 v[56:59], v10 offset:36864
    buffer_load_dwordx4 v[176:179], v15, s[40:43], s84 offen sc1
    s_waitcnt lgkmcnt(3)
    v_mfma_f32_16x16x32_bf16 v[76:79], v[132:135], v[44:47], v[76:79]
    ds_read_b128 v[60:63], v18 offset:36864
    buffer_load_dwordx4 v[180:183], v36, s[40:43], s84 offen sc1
    s_waitcnt lgkmcnt(3)
    v_mfma_f32_16x16x32_bf16 v[80:83], v[132:135], v[48:51], v[80:83]
    ds_read_b128 v[64:67], v19 offset:36864
    s_waitcnt lgkmcnt(3)
    v_mfma_f32_16x16x32_bf16 v[84:87], v[132:135], v[52:55], v[84:87]
    ds_read_b128 v[68:71], v37 offset:36864
    s_waitcnt lgkmcnt(3)
    v_mfma_f32_16x16x32_bf16 v[72:75], v[128:131], v[56:59], v[72:75]
    ds_read_b128 v[40:43], v10 offset:40960
    buffer_load_dwordx4 v[168:171], v15, s[40:43], s85 offen sc1
    s_waitcnt lgkmcnt(3)
    v_mfma_f32_16x16x32_bf16 v[76:79], v[128:131], v[60:63], v[76:79]
    ds_read_b128 v[44:47], v18 offset:40960
    buffer_load_dwordx4 v[172:175], v36, s[40:43], s85 offen sc1
    s_waitcnt lgkmcnt(3)
    v_mfma_f32_16x16x32_bf16 v[80:83], v[128:131], v[64:67], v[80:83]
    ds_read_b128 v[48:51], v19 offset:40960
    s_waitcnt lgkmcnt(3)
    v_mfma_f32_16x16x32_bf16 v[84:87], v[128:131], v[68:71], v[84:87]
    ds_read_b128 v[52:55], v37 offset:40960
    s_waitcnt lgkmcnt(3)
    v_mfma_f32_16x16x32_bf16 v[72:75], v[104:107], v[40:43], v[72:75]
    ds_read_b128 v[56:59], v10 offset:45056
    buffer_load_dwordx4 v[160:163], v15, s[40:43], s86 offen sc1
    s_waitcnt lgkmcnt(3)
    v_mfma_f32_16x16x32_bf16 v[76:79], v[104:107], v[44:47], v[76:79]
    ds_read_b128 v[60:63], v18 offset:45056
    buffer_load_dwordx4 v[164:167], v36, s[40:43], s86 offen sc1
    s_waitcnt lgkmcnt(3)
    v_mfma_f32_16x16x32_bf16 v[80:83], v[104:107], v[48:51], v[80:83]
    ds_read_b128 v[64:67], v19 offset:45056
    s_waitcnt lgkmcnt(3)
    v_mfma_f32_16x16x32_bf16 v[84:87], v[104:107], v[52:55], v[84:87]
    ds_read_b128 v[68:71], v37 offset:45056
    s_waitcnt lgkmcnt(3)
    v_mfma_f32_16x16x32_bf16 v[72:75], v[108:111], v[56:59], v[72:75]
    ds_read_b128 v[40:43], v10 offset:49152
    buffer_load_dwordx4 v[152:155], v15, s[40:43], s87 offen sc1
    s_waitcnt lgkmcnt(3)
    v_mfma_f32_16x16x32_bf16 v[76:79], v[108:111], v[60:63], v[76:79]
    ds_read_b128 v[44:47], v18 offset:49152
    buffer_load_dwordx4 v[156:159], v36, s[40:43], s87 offen sc1
    s_waitcnt lgkmcnt(3)
    v_mfma_f32_16x16x32_bf16 v[80:83], v[108:111], v[64:67], v[80:83]
    ds_read_b128 v[48:51], v19 offset:49152
    s_waitcnt lgkmcnt(3)
    v_mfma_f32_16x16x32_bf16 v[84:87], v[108:111], v[68:71], v[84:87]
    ds_read_b128 v[52:55], v37 offset:49152
    buffer_load_dwordx4 v[88:91], v24, s[40:43], s16 offen sc1
    buffer_load_dwordx4 v[92:95], v24, s[40:43], s17 offen sc1
    s_waitcnt lgkmcnt(3)
    v_mfma_f32_16x16x32_bf16 v[72:75], v[112:115], v[40:43], v[72:75]
    ds_read_b128 v[56:59], v10 offset:53248
    buffer_load_dwordx4 v[144:147], v15, s[40:43], s88 offen sc1
    s_waitcnt lgkmcnt(3)
    v_mfma_f32_16x16x32_bf16 v[76:79], v[112:115], v[44:47], v[76:79]
    ds_read_b128 v[60:63], v18 offset:53248
    buffer_load_dwordx4 v[148:151], v36, s[40:43], s88 offen sc1
    s_waitcnt lgkmcnt(3)
    v_mfma_f32_16x16x32_bf16 v[80:83], v[112:115], v[48:51], v[80:83]
    ds_read_b128 v[64:67], v19 offset:53248
    s_waitcnt lgkmcnt(3)
    v_mfma_f32_16x16x32_bf16 v[84:87], v[112:115], v[52:55], v[84:87]
    ds_read_b128 v[68:71], v37 offset:53248
    s_waitcnt lgkmcnt(3)
    v_mfma_f32_16x16x32_bf16 v[72:75], v[116:119], v[56:59], v[72:75]
    ds_read_b128 v[40:43], v10 offset:57344
    buffer_load_dwordx4 v[136:139], v15, s[40:43], s89 offen sc1
    s_waitcnt lgkmcnt(3)
    v_mfma_f32_16x16x32_bf16 v[76:79], v[116:119], v[60:63], v[76:79]
    ds_read_b128 v[44:47], v18 offset:57344
    buffer_load_dwordx4 v[140:143], v36, s[40:43], s89 offen sc1
    s_waitcnt lgkmcnt(3)
    v_mfma_f32_16x16x32_bf16 v[80:83], v[116:119], v[64:67], v[80:83]
    ds_read_b128 v[48:51], v19 offset:57344
    s_waitcnt lgkmcnt(3)
    v_mfma_f32_16x16x32_bf16 v[84:87], v[116:119], v[68:71], v[84:87]
    ds_read_b128 v[52:55], v37 offset:57344
    s_waitcnt lgkmcnt(3)
    v_mfma_f32_16x16x32_bf16 v[72:75], v[120:123], v[40:43], v[72:75]
    ds_read_b128 v[56:59], v10 offset:61440
    buffer_load_dwordx4 v[128:131], v15, s[40:43], s90 offen sc1
    s_waitcnt lgkmcnt(3)
    v_mfma_f32_16x16x32_bf16 v[76:79], v[120:123], v[44:47], v[76:79]
    ds_read_b128 v[60:63], v18 offset:61440
    buffer_load_dwordx4 v[132:135], v36, s[40:43], s90 offen sc1
    s_waitcnt lgkmcnt(3)
    v_mfma_f32_16x16x32_bf16 v[80:83], v[120:123], v[48:51], v[80:83]
    ds_read_b128 v[64:67], v19 offset:61440
    s_waitcnt lgkmcnt(3)
    v_mfma_f32_16x16x32_bf16 v[84:87], v[120:123], v[52:55], v[84:87]
    ds_read_b128 v[68:71], v37 offset:61440
    s_waitcnt lgkmcnt(3)
    v_mfma_f32_16x16x32_bf16 v[72:75], v[124:127], v[56:59], v[72:75]
    s_waitcnt lgkmcnt(2)
    v_mfma_f32_16x16x32_bf16 v[76:79], v[124:127], v[60:63], v[76:79]
    s_waitcnt lgkmcnt(1)
    v_mfma_f32_16x16x32_bf16 v[80:83], v[124:127], v[64:67], v[80:83]
    s_waitcnt lgkmcnt(0)
    v_mfma_f32_16x16x32_bf16 v[84:87], v[124:127], v[68:71], v[84:87]
    s_waitcnt vmcnt(6)
    s_mov_b32 s63, 0
.l2_45:
    v_xor_b32 v96, s62, v90
    v_bitop3_b32 v96, v96, v94, s62 bitop3:0xf6
    v_cmp_ne_u32 vcc, 0, v96
    s_cbranch_vccz .l2x_46
    s_add_u32 s63, s63, 1
    s_cmp_gt_u32 s63, 262144
    s_cbranch_scc1 .l2x_46
    buffer_load_dwordx4 v[88:91], v24, s[40:43], s16 offen sc1
    buffer_load_dwordx4 v[92:95], v24, s[40:43], s17 offen sc1
    s_waitcnt vmcnt(0)
    s_branch .l2_45
.l2x_46:
    v_pk_add_f32 v[88:89], v[88:89], v[92:93]
    s_nop 0
    v_mov_b32 v92, v88
    v_mov_b32 v93, v89
    s_nop 1
    v_permlane32_swap_b32 v88, v92
    v_permlane32_swap_b32 v89, v93
    v_pk_add_f32 v[88:89], v[88:89], v[92:93]
    s_nop 0
    v_mov_b32 v92, v88
    v_mov_b32 v93, v89
    s_nop 1
    v_permlane16_swap_b32 v88, v92
    v_permlane16_swap_b32 v89, v93
    v_add_f32 v88, v88, v92
    v_add_f32 v89, v89, v93
    v_mul_f32 v88, 0x3b000000, v88
    v_mul_f32 v89, 0x3b000000, v89
    v_fma_f32 v89, -v88, v88, v89
    v_max_f32 v89, 0, v89
    v_cvt_pk_bf16_f32 v92, v89, v88
    v_lshlrev_b32 v89, 16, v92
    v_and_b32 v88, 0xffff0000, v92
    v_add_f32 v89, 0x3727c5ac, v89
    v_cvt_pk_bf16_f32 v89, v89, v89
    v_and_b32 v89, 0xffff0000, v89
    v_sqrt_f32 v89, v89
    s_nop 0
    v_cvt_pk_bf16_f32 v89, v89, v89
    v_and_b32 v89, 0xffff0000, v89
    v_rcp_f32 v89, v89
    s_nop 0
    v_mul_f32 v88, -v88, v89
    s_lshl_b32 s60, s47, 7
    v_lshl_add_u32 v14, v6, 3, s60
    ds_write_b64 v14, v[88:89] offset:640
    v_xor_b32 v43, 0x80, v16
    v_xor_b32 v44, 0x100, v16
    v_xor_b32 v45, 0x180, v16
    s_waitcnt lgkmcnt(0)
    s_barrier
    ds_read_b64 v[50:51], v16 offset:640
    ds_read_b64 v[52:53], v43 offset:640
    ds_read_b64 v[54:55], v44 offset:640
    ds_read_b64 v[56:57], v45 offset:640
    s_waitcnt lgkmcnt(3)
    v_pk_fma_f32 v[58:59], v[50:51], v[20:21], v[28:29] op_sel_hi:[0,1,1]
    v_pk_fma_f32 v[60:61], v[50:51], v[22:23], v[30:31] op_sel_hi:[0,1,1]
    v_pk_fma_f32 v[72:73], v[72:73], v[50:51], v[58:59] op_sel:[0,1,0] op_sel_hi:[1,1,1]
    v_pk_fma_f32 v[74:75], v[74:75], v[50:51], v[60:61] op_sel:[0,1,0] op_sel_hi:[1,1,1]
    v_cvt_pk_bf16_f32 v72, v72, v73
    v_cvt_pk_bf16_f32 v73, v74, v75
    v_pk_max_i16 v72, v72, 0
    v_pk_max_i16 v73, v73, 0
    s_waitcnt lgkmcnt(2)
    v_pk_fma_f32 v[58:59], v[52:53], v[20:21], v[28:29] op_sel_hi:[0,1,1]
    v_pk_fma_f32 v[60:61], v[52:53], v[22:23], v[30:31] op_sel_hi:[0,1,1]
    v_pk_fma_f32 v[76:77], v[76:77], v[52:53], v[58:59] op_sel:[0,1,0] op_sel_hi:[1,1,1]
    v_pk_fma_f32 v[78:79], v[78:79], v[52:53], v[60:61] op_sel:[0,1,0] op_sel_hi:[1,1,1]
    v_cvt_pk_bf16_f32 v74, v76, v77
    v_cvt_pk_bf16_f32 v75, v78, v79
    v_pk_max_i16 v74, v74, 0
    v_pk_max_i16 v75, v75, 0
    s_add_u32 s66, s18, s58
    s_nop 0
    v_permlane16_swap_b32 v72, v74
    v_permlane16_swap_b32 v73, v75
    buffer_store_dwordx4 v[72:75], v38, s[40:43], s66 offen
    s_waitcnt lgkmcnt(1)
    v_pk_fma_f32 v[58:59], v[54:55], v[20:21], v[28:29] op_sel_hi:[0,1,1]
    v_pk_fma_f32 v[60:61], v[54:55], v[22:23], v[30:31] op_sel_hi:[0,1,1]
    v_pk_fma_f32 v[80:81], v[80:81], v[54:55], v[58:59] op_sel:[0,1,0] op_sel_hi:[1,1,1]
    v_pk_fma_f32 v[82:83], v[82:83], v[54:55], v[60:61] op_sel:[0,1,0] op_sel_hi:[1,1,1]
    v_cvt_pk_bf16_f32 v80, v80, v81
    v_cvt_pk_bf16_f32 v81, v82, v83
    v_pk_max_i16 v80, v80, 0
    v_pk_max_i16 v81, v81, 0
    s_waitcnt lgkmcnt(0)
    v_pk_fma_f32 v[58:59], v[56:57], v[20:21], v[28:29] op_sel_hi:[0,1,1]
    v_pk_fma_f32 v[60:61], v[56:57], v[22:23], v[30:31] op_sel_hi:[0,1,1]
    v_pk_fma_f32 v[84:85], v[84:85], v[56:57], v[58:59] op_sel:[0,1,0] op_sel_hi:[1,1,1]
    v_pk_fma_f32 v[86:87], v[86:87], v[56:57], v[60:61] op_sel:[0,1,0] op_sel_hi:[1,1,1]
    v_cvt_pk_bf16_f32 v82, v84, v85
    v_cvt_pk_bf16_f32 v83, v86, v87
    v_pk_max_i16 v82, v82, 0
    v_pk_max_i16 v83, v83, 0
    s_add_u32 s66, s19, s58
    s_nop 0
    v_permlane16_swap_b32 v80, v82
    v_permlane16_swap_b32 v81, v83
    buffer_store_dwordx4 v[80:83], v38, s[40:43], s66 offen
    s_waitcnt vmcnt(0)
    v_mov_b32 v4, 1
    s_mov_b64 exec, 1
    ds_add_rtn_u32 v4, v5, v4 offset:52
    s_mov_b64 exec, -1
    s_waitcnt lgkmcnt(0)
    v_readfirstlane_b32 s63, v4
    s_cmp_eq_u32 s63, 7
    s_cselect_b32 s28, s28, 1073741824
    s_cmp_eq_u32 s51, 0
    s_cbranch_scc1 .slow_47
    buffer_store_dword v39, v5, s[40:43], s28 offen
    s_branch .pubd_48
.slow_47:
    buffer_wbl2 sc1
    s_waitcnt vmcnt(0)
    buffer_store_dword v39, v5, s[40:43], s28 offen sc1
.pubd_48:
    buffer_load_dword v4, v8, s[40:43], s29 offen sc1
    s_waitcnt vmcnt(0)
    s_mov_b32 s63, 0
    v_cmp_ne_u32 vcc, s62, v4
    s_cbranch_vccz .pok_49
    s_mov_b32 s63, 0
.poll_50:
    buffer_load_dword v4, v8, s[40:43], s29 offen sc1
    s_add_u32 s63, s63, 1
    s_cmp_gt_u32 s63, 262144
    s_cbranch_scc1 .pollx_51
    s_waitcnt vmcnt(0)
    v_cmp_ne_u32 vcc, s62, v4
    s_cbranch_vccz .pollx_51
    s_sleep 1
    s_branch .poll_50
.pollx_51:
.pok_49:
    buffer_load_dwordx4 v[104:107], v11, s[40:43], s78 offen sc1
    buffer_load_dwordx4 v[108:111], v12, s[40:43], s78 offen sc1
    buffer_load_dwordx4 v[112:115], v11, s[40:43], s79 offen sc1
    buffer_load_dwordx4 v[116:119], v12, s[40:43], s79 offen sc1
    s_waitcnt vmcnt(2)
    v_mfma_f32_32x32x16_bf16 v[40:55], v[224:227], v[104:107], 0
    buffer_load_dwordx4 v[120:123], v11, s[40:43], s80 offen sc1
    v_mfma_f32_32x32x16_bf16 v[56:71], v[224:227], v[108:111], 0
    buffer_load_dwordx4 v[124:127], v12, s[40:43], s80 offen sc1
    v_mfma_f32_32x32x16_bf16 v[72:87], v[228:231], v[104:107], 0
    v_mfma_f32_32x32x16_bf16 v[88:103], v[228:231], v[108:111], 0
    s_waitcnt vmcnt(2)
    v_mfma_f32_32x32x16_bf16 v[40:55], v[216:219], v[112:115], v[40:55]
    buffer_load_dwordx4 v[104:107], v11, s[40:43], s81 offen sc1
    v_mfma_f32_32x32x16_bf16 v[56:71], v[216:219], v[116:119], v[56:71]
    buffer_load_dwordx4 v[108:111], v12, s[40:43], s81 offen sc1
    v_mfma_f32_32x32x16_bf16 v[72:87], v[220:223], v[112:115], v[72:87]
    v_mfma_f32_32x32x16_bf16 v[88:103], v[220:223], v[116:119], v[88:103]
    s_waitcnt vmcnt(2)
    v_mfma_f32_32x32x16_bf16 v[40:55], v[208:211], v[120:123], v[40:55]
    buffer_load_dwordx4 v[112:115], v11, s[40:43], s82 offen sc1
    v_mfma_f32_32x32x16_bf16 v[56:71], v[208:211], v[124:127], v[56:71]
    buffer_load_dwordx4 v[116:119], v12, s[40:43], s82 offen sc1
    v_mfma_f32_32x32x16_bf16 v[72:87], v[212:215], v[120:123], v[72:87]
    v_mfma_f32_32x32x16_bf16 v[88:103], v[212:215], v[124:127], v[88:103]
    s_waitcnt vmcnt(2)
    v_mfma_f32_32x32x16_bf16 v[40:55], v[200:203], v[104:107], v[40:55]
    buffer_load_dwordx4 v[120:123], v11, s[40:43], s83 offen sc1
    v_mfma_f32_32x32x16_bf16 v[56:71], v[200:203], v[108:111], v[56:71]
    buffer_load_dwordx4 v[124:127], v12, s[40:43], s83 offen sc1
    v_mfma_f32_32x32x16_bf16 v[72:87], v[204:207], v[104:107], v[72:87]
    v_mfma_f32_32x32x16_bf16 v[88:103], v[204:207], v[108:111], v[88:103]
    s_waitcnt vmcnt(2)
    v_mfma_f32_32x32x16_bf16 v[40:55], v[192:195], v[112:115], v[40:55]
    buffer_load_dwordx4 v[104:107], v11, s[40:43], s84 offen sc1
    v_mfma_f32_32x32x16_bf16 v[56:71], v[192:195], v[116:119], v[56:71]
    buffer_load_dwordx4 v[108:111], v12, s[40:43], s84 offen sc1
    v_mfma_f32_32x32x16_bf16 v[72:87], v[196:199], v[112:115], v[72:87]
    v_mfma_f32_32x32x16_bf16 v[88:103], v[196:199], v[116:119], v[88:103]
    s_waitcnt vmcnt(2)
    v_mfma_f32_32x32x16_bf16 v[40:55], v[184:187], v[120:123], v[40:55]
    buffer_load_dwordx4 v[112:115], v11, s[40:43], s85 offen sc1
    v_mfma_f32_32x32x16_bf16 v[56:71], v[184:187], v[124:127], v[56:71]
    buffer_load_dwordx4 v[116:119], v12, s[40:43], s85 offen sc1
    v_mfma_f32_32x32x16_bf16 v[72:87], v[188:191], v[120:123], v[72:87]
    v_mfma_f32_32x32x16_bf16 v[88:103], v[188:191], v[124:127], v[88:103]
    s_waitcnt vmcnt(2)
    v_mfma_f32_32x32x16_bf16 v[40:55], v[176:179], v[104:107], v[40:55]
    buffer_load_dwordx4 v[120:123], v11, s[40:43], s86 offen sc1
    v_mfma_f32_32x32x16_bf16 v[56:71], v[176:179], v[108:111], v[56:71]
    buffer_load_dwordx4 v[124:127], v12, s[40:43], s86 offen sc1
    v_mfma_f32_32x32x16_bf16 v[72:87], v[180:183], v[104:107], v[72:87]
    v_mfma_f32_32x32x16_bf16 v[88:103], v[180:183], v[108:111], v[88:103]
    s_waitcnt vmcnt(2)
    v_mfma_f32_32x32x16_bf16 v[40:55], v[168:171], v[112:115], v[40:55]
    buffer_load_dwordx4 v[104:107], v11, s[40:43], s87 offen sc1
    v_mfma_f32_32x32x16_bf16 v[56:71], v[168:171], v[116:119], v[56:71]
    buffer_load_dwordx4 v[108:111], v12, s[40:43], s87 offen sc1
    v_mfma_f32_32x32x16_bf16 v[72:87], v[172:175], v[112:115], v[72:87]
    v_mfma_f32_32x32x16_bf16 v[88:103], v[172:175], v[116:119], v[88:103]
    s_waitcnt vmcnt(2)
    v_mfma_f32_32x32x16_bf16 v[40:55], v[160:163], v[120:123], v[40:55]
    buffer_load_dwordx4 v[112:115], v11, s[40:43], s88 offen sc1
    v_mfma_f32_32x32x16_bf16 v[56:71], v[160:163], v[124:127], v[56:71]
    buffer_load_dwordx4 v[116:119], v12, s[40:43], s88 offen sc1
    v_mfma_f32_32x32x16_bf16 v[72:87], v[164:167], v[120:123], v[72:87]
    v_mfma_f32_32x32x16_bf16 v[88:103], v[164:167], v[124:127], v[88:103]
    s_waitcnt vmcnt(2)
    v_mfma_f32_32x32x16_bf16 v[40:55], v[152:155], v[104:107], v[40:55]
    buffer_load_dwordx4 v[120:123], v11, s[40:43], s89 offen sc1
    v_mfma_f32_32x32x16_bf16 v[56:71], v[152:155], v[108:111], v[56:71]
    buffer_load_dwordx4 v[124:127], v12, s[40:43], s89 offen sc1
    v_mfma_f32_32x32x16_bf16 v[72:87], v[156:159], v[104:107], v[72:87]
    v_mfma_f32_32x32x16_bf16 v[88:103], v[156:159], v[108:111], v[88:103]
    buffer_load_dwordx4 v[104:107], v11, s[40:43], s90 offen sc1
    buffer_load_dwordx4 v[108:111], v12, s[40:43], s90 offen sc1
    s_waitcnt vmcnt(4)
    v_mfma_f32_32x32x16_bf16 v[88:103], v[148:151], v[116:119], v[88:103]
    s_waitcnt vmcnt(2)
    v_mfma_f32_32x32x16_bf16 v[88:103], v[140:143], v[124:127], v[88:103]
    s_waitcnt vmcnt(0)
    v_mfma_f32_32x32x16_bf16 v[88:103], v[132:135], v[108:111], v[88:103]
    v_mfma_f32_32x32x16_bf16 v[72:87], v[148:151], v[112:115], v[72:87]
    s_nop 5
    v_mfma_f32_32x32x16_bf16 v[72:87], v[140:143], v[120:123], v[72:87]
    s_nop 3
    ds_write_b128 v254, v[88:91] offset:10240
    v_mfma_f32_32x32x16_bf16 v[72:87], v[132:135], v[104:107], v[72:87]
    ds_write_b128 v254, v[92:95] offset:11264
    ds_write_b128 v255, v[96:99] offset:12288
    v_mfma_f32_32x32x16_bf16 v[56:71], v[144:147], v[116:119], v[56:71]
    ds_write_b128 v255, v[100:103] offset:13312
    s_nop 2
    v_mfma_f32_32x32x16_bf16 v[56:71], v[136:139], v[124:127], v[56:71]
    s_nop 5
    v_mfma_f32_32x32x16_bf16 v[56:71], v[128:131], v[108:111], v[56:71]
    ds_write_b128 v252, v[72:75] offset:6144
    ds_write_b128 v252, v[76:79] offset:7168
    v_mfma_f32_32x32x16_bf16 v[40:55], v[144:147], v[112:115], v[40:55]
    ds_write_b128 v253, v[80:83] offset:8192
    ds_write_b128 v253, v[84:87] offset:9216
    v_mfma_f32_32x32x16_bf16 v[40:55], v[136:139], v[120:123], v[40:55]
    s_nop 5
    v_mfma_f32_32x32x16_bf16 v[40:55], v[128:131], v[104:107], v[40:55]
    s_nop 0
    ds_write_b128 v250, v[56:59] offset:2048
    ds_write_b128 v250, v[60:63] offset:3072
    ds_write_b128 v251, v[64:67] offset:4096
    ds_write_b128 v251, v[68:71] offset:5120
    s_nop 9
    ds_write_b128 v249, v[48:51] offset:0
    ds_write_b128 v249, v[52:55] offset:1024
    s_branch .join_3
.side_2:
    v_and_b32 v8, 31, v1
    v_mov_b32 v24, 0
    v_mov_b32 v25, 0
    v_mov_b32 v26, 0
    v_mov_b32 v27, 0
    v_lshlrev_b32 v28, 2, v8
    ds_write_b32 v28, v24
    v_lshrrev_b32 v28, 5, v1
    v_mul_u32_u24 v28, 4608, v28
    v_lshl_add_u32 v28, v8, 4, v28
    ds_write_b128 v28, v[24:27] offset:53760
    v_mul_u32_u24 v29, 4160, v4
    ds_write_b128 v29, v[24:27] offset:16384
    s_getreg_b32 s61, hwreg(HW_REG_XCC_ID, 0, 4)
    s_lshl_b32 s65, s2, 7
    s_add_u32 s65, s65, 17170432
    s_cmp_eq_u32 s47, 0
    s_cselect_b32 s65, s65, 1073741824
    s_lshl_b32 s61, s61, 28
    s_lshl_b32 s56, s57, 12
    s_lshl_b32 s58, s47, 10
    s_add_u32 s58, s58, s56
    s_add_u32 s59, s58, 0x1000
    v_bfe_u32 v31, v1, 2, 1
    v_lshlrev_b32 v31, 12, v31
    s_lshr_b32 s52, s2, 2
    s_and_b32 s53, s2, 3
    s_lshl_b32 s53, s53, 2
    s_add_u32 s53, s53, s47
    v_lshrrev_b32 v12, 2, v1
    v_and_b32 v13, 3, v1
    v_mul_u32_u24 v16, 2752, v12
    v_lshl_add_u32 v16, v13, 4, v16
    v_lshlrev_b32 v12, 10, v12
    v_lshl_add_u32 v12, v13, 4, v12
    s_lshl_b32 s96, s45, 1
    s_and_b32 s68, s47, 1
    s_add_u32 s96, s96, s68
    s_lshl_b32 s97, s44, 1
    s_lshr_b32 s68, s47, 1
    s_add_u32 s97, s97, s68
    s_mul_i32 s54, s97, 88064
    s_lshl_b32 s68, s96, 6
    s_add_u32 s54, s54, s68
    s_cmp_lt_u32 s96, 43
    s_cselect_b32 s54, s54, 1073741824
    s_sub_u32 s67, s2, 64
    s_and_b32 s67, s67, 255
    s_mul_i32 s68, s67, 171
    s_lshr_b32 s68, s68, 13
    s_mul_i32 s66, s68, 48
    s_sub_u32 s67, s67, s66
    s_and_b32 s68, s68, 3
    s_lshl_b32 s66, s68, 7
    s_lshl_b32 s70, s47, 5
    s_add_u32 s66, s66, s70
    v_add_u32 v11, s66, v8
    v_lshlrev_b32 v11, 1, v11
    s_mul_i32 s69, s66, 6144
    s_lshl_b32 s70, s67, 7
    s_add_u32 s69, s69, s70
    s_mul_i32 s55, s68, 24576
    s_lshl_b32 s70, s67, 9
    s_add_u32 s55, s55, s70
    s_lshl_b32 s70, s47, 7
    s_add_u32 s55, s55, s70
    s_add_u32 s55, s55, 17727488
    s_cmp_ge_u32 s2, 64
    s_cselect_b32 s69, s69, 1073741824
    s_cselect_b32 s55, s55, 1073741824
    v_mul_u32_u24 v15, 6144, v10
    v_lshl_add_u32 v15, v4, 4, v15
    s_lshl_b32 s68, s47, 12
    s_mov_b32 s34, 0x200000
    s_mov_b32 s35, 0x20000
    s_mov_b32 s39, 0x20000
    s_mov_b32 s30, 0x300000
    s_mov_b32 s31, 0x20000
    s_waitcnt lgkmcnt(0)
    s_load_dword s62, s[26:27], s60
    s_mov_b32 s40, s26
    s_mov_b32 s41, s27
    s_mov_b32 s32, s12
    s_mov_b32 s33, s13
    s_mov_b32 s8, s16
    s_mov_b32 s9, s17
    s_mov_b32 s10, 1409024
    s_mov_b32 s11, 0x20000
    s_mov_b32 s28, s22
    s_mov_b32 s29, s23
    s_mov_b32 s22, s55
    s_mov_b32 s55, s54
    v_lshl_add_u32 v20, v8, 3, s44
    v_lshlrev_b32 v20, 7, v20
    s_lshl_b32 s60, s47, 10
    s_add_u32 s60, s60, 16416
    v_add_u32 v28, s60, v9
    v_lshlrev_b32 v30, 4, v13
    v_sub_u32 v30, 48, v30
    s_waitcnt lgkmcnt(0)
    s_add_u32 s62, s62, 1
    s_xor_b32 s61, s61, s62
    v_mov_b32 v24, s61
    buffer_store_dword v24, v5, s[40:43], s65 offen sc1
    s_barrier
    s_lshl_b32 s64, s47, 11
    s_add_u32 m0, s64, 92672
    s_nop 0
    buffer_load_dwordx4 v16, s[8:11], s55 offen lds
    s_add_u32 m0, s64, 93696
    s_add_u32 s55, s55, 44032
    buffer_load_dwordx4 v16, s[8:11], s55 offen lds
    buffer_load_dwordx4 v[200:203], v9, s[32:35], s58 offen offset:0 nt
    buffer_load_dwordx4 v[212:215], v9, s[32:35], s59 offen offset:0 nt
    buffer_load_dwordx4 v[204:207], v9, s[32:35], s58 offen offset:4 nt
    buffer_load_dwordx4 v[216:219], v9, s[32:35], s59 offen offset:4 nt
    buffer_load_dwordx4 v[208:211], v9, s[32:35], s58 offen offset:8 nt
    buffer_load_dwordx4 v[220:223], v9, s[32:35], s59 offen offset:8 nt
    buffer_load_dwordx2 v[224:225], v31, s[32:35], s56 offen
    global_load_ushort v11, v11, s[20:21]
    v_bfe_u32 v21, v1, 2, 2
    v_lshl_add_u32 v17, v7, 3, v21
    v_lshlrev_b32 v17, 6, v17
    v_lshl_add_u32 v17, v13, 3, v17
    s_add_u32 s60, s64, 92672
    v_add_u32 v17, s60, v17
    v_lshrrev_b32 v22, 5, v1
    v_lshl_add_u32 v18, v22, 3, v21
    v_lshlrev_b32 v18, 6, v18
    v_and_b32 v22, 1, v7
    v_lshl_add_u32 v18, v22, 5, v18
    v_lshl_add_u32 v18, v13, 3, v18
    s_add_u32 s60, s64, 100864
    v_add_u32 v18, s60, v18
    v_mov_b32 v19, s62
    s_lshl_b32 s65, s96, 15
    s_lshl_b32 s66, s97, 10
    s_add_u32 s65, s65, s66
    s_add_u32 s65, s65, 6291456
    s_mul_i32 s56, s53, 88064
    s_lshl_b32 s66, s52, 11
    s_add_u32 s56, s56, s66
    s_add_u32 s56, s56, 8388608
    s_lshl_b32 s57, s2, 7
    s_add_u32 s23, s57, 17072128
    s_add_u32 s57, s57, 17039360
    s_cmp_lt_u32 s96, 43
    s_cselect_b32 s16, s65, 1073741824
    s_cmp_lt_u32 s2, 176
    s_cselect_b32 s57, s57, 1073741824
    s_cmp_lt_u32 s2, 172
    s_cselect_b32 s56, s56, 1073741824
    s_cselect_b32 s23, s23, 1073741824
    s_add_u32 s17, s16, 0x4000
    s_mov_b32 s32, s18
    s_mov_b32 s33, s19
    s_mov_b32 s34, 1409024
    s_mov_b32 s36, s4
    s_mov_b32 s37, s5
    s_mov_b32 s38, 0x200000
    s_lshl_b32 s12, s49, 16
    s_lshl_b32 s13, s47, 14
    s_add_u32 s12, s12, s13
    s_lshl_b32 s13, s48, 7
    s_add_u32 s12, s12, s13
    s_lshl_b32 s13, s52, 15
    s_lshl_b32 s60, s53, 6
    s_add_u32 s13, s13, s60
    v_lshl_add_u32 v25, v7, 3, v21
    v_lshlrev_b32 v25, 7, v25
    v_lshl_add_u32 v25, v13, 3, v25
    s_lshl_b32 s60, s47, 5
    s_add_u32 s60, s60, 117248
    v_add_u32 v22, s60, v25
    v_lshlrev_b32 v23, 4, v7
    s_mov_b32 s60, 17170432
    s_cmp_eq_u32 s47, 0
    s_cselect_b32 s60, s60, 1073741824
    v_mov_b32 v26, s57
    v_writelane_b32 v26, s23, 1
    v_writelane_b32 v26, s22, 2
    s_lshl_b32 s70, s2, 10
    s_lshl_b32 s71, s47, 8
    s_add_u32 s70, s70, s71
    s_add_u32 s70, s70, 17203200
    v_writelane_b32 v26, s70, 3
    s_add_u32 s70, s70, 128
    v_writelane_b32 v26, s70, 4
    buffer_load_dword v250, v26, s[40:43], 0 offen sc1
    s_sleep 3
    buffer_load_dword v14, v20, s[40:43], s60 offen sc1
    s_waitcnt vmcnt(10)
    ds_read_b64_tr_b16 v[32:33], v17
    ds_read_b64_tr_b16 v[34:35], v17 offset:256
    ds_read_b64_tr_b16 v[36:37], v17 offset:32
    ds_read_b64_tr_b16 v[38:39], v17 offset:288
    s_waitcnt lgkmcnt(0)
    buffer_store_dwordx4 v[32:35], v9, s[40:43], s16 offen sc1
    buffer_store_dwordx4 v[36:39], v9, s[40:43], s17 offen sc1
    s_waitcnt vmcnt(2)
    s_cmp_lg_u32 s47, 0
    s_cbranch_scc1 .noxc_52
    s_mov_b32 s63, 0
    s_mov_b32 s60, 17170432
.xcl_53:
    v_xor_b32 v14, s61, v14
    v_lshlrev_b32 v26, 4, v14
    v_cmp_ne_u32 vcc, 0, v26
    s_cbranch_vccz .noxc_52y
    s_add_u32 s63, s63, 1
    s_cmp_gt_u32 s63, 64
    s_cbranch_scc1 .noxc_52y
    buffer_load_dword v14, v20, s[40:43], s60 offen sc1
    s_waitcnt vmcnt(0)
    s_branch .xcl_53
.noxc_52y:
    v_cmp_ne_u32 vcc, 0, v14
    s_cmp_eq_u64 vcc, 0
    s_cselect_b32 s51, 2, 1
    v_mov_b32 v14, s51
    ds_write_b32 v5, v14 offset:12
.noxc_52:
    s_waitcnt vmcnt(4)
    ds_write_b128 v28, v[200:203] offset:0
    ds_write_b128 v28, v[204:207] offset:8320
    v_alignbit_b32 v228, v204, v200, 16
    v_alignbit_b32 v229, v205, v201, 16
    v_alignbit_b32 v230, v206, v202, 16
    v_alignbit_b32 v231, v207, v203, 16
    v_alignbit_b32 v232, v208, v204, 16
    v_alignbit_b32 v233, v209, v205, 16
    v_alignbit_b32 v234, v210, v206, 16
    v_alignbit_b32 v235, v211, v207, 16
    ds_write_b128 v28, v[228:231] offset:4160
    ds_write_b128 v28, v[232:235] offset:12480
    ds_write_b128 v28, v[212:215] offset:16640
    ds_write_b128 v28, v[216:219] offset:24960
    v_alignbit_b32 v228, v216, v212, 16
    v_alignbit_b32 v229, v217, v213, 16
    v_alignbit_b32 v230, v218, v214, 16
    v_alignbit_b32 v231, v219, v215, 16
    v_alignbit_b32 v232, v220, v216, 16
    v_alignbit_b32 v233, v221, v217, 16
    v_alignbit_b32 v234, v222, v218, 16
    v_alignbit_b32 v235, v223, v219, 16
    ds_write_b128 v28, v[228:231] offset:20800
    ds_write_b128 v28, v[232:235] offset:29120
    v_lshlrev_b64 v[224:225], v30, v[224:225]
    v_mov_b32 v24, 0
    v_mov_b32 v25, 0
    v_lshlrev_b64 v[26:27], 16, v[224:225]
    ds_write_b128 v29, v[24:27] offset:16400
    v_lshlrev_b32 v11, 16, v11
    v_mul_f32 v24, 0xbfb8aa3b, v11
    v_exp_f32 v24, v24
    s_lshl_b32 s60, s47, 6
    v_add_f32 v24, 1.0, v24
    v_rcp_f32 v24, v24
    v_lshl_add_u32 v29, v8, 1, s60
    v_mul_f32 v11, v11, v24
    v_cvt_pk_bf16_f32 v11, v11, v11
    ds_write_b16 v29, v11 offset:3456
    s_waitcnt lgkmcnt(1)
    v_mov_b32 v24, 1
    s_mov_b64 exec, 1
    ds_add_u32 v5, v24 offset:4
    s_mov_b64 exec, -1
    s_mov_b32 s18, s57
    s_waitcnt vmcnt(0)
    v_mov_b32 v24, 1
    s_mov_b64 exec, 1
    ds_add_rtn_u32 v24, v5, v24 offset:24
    s_mov_b64 exec, -1
    s_waitcnt lgkmcnt(0)
    v_readfirstlane_b32 s63, v24
    s_cmp_eq_u32 s63, 3
    s_cselect_b32 s18, s18, 1073741824
    buffer_store_dword v19, v5, s[40:43], s18 offen sc1
    s_lshl_b32 s21, s50, 2
    s_mul_i32 s52, s48, 11
    s_cmp_eq_u32 s48, 7
    s_cselect_b32 s20, 1, 0
    s_sub_u32 s52, s52, s20
    s_cmp_ge_u32 s48, 6
    s_cselect_b32 s20, 10, 11
    s_add_u32 s60, s47, 0
    s_add_u32 s61, s60, s52
    s_lshl_b32 s53, s61, 14
    s_add_u32 s53, s53, 6291456
    s_lshl_b32 s58, s61, 10
    s_cmp_lt_u32 s60, s20
    s_cselect_b32 s53, s53, 1073741824
    s_cselect_b32 s58, s58, 1073741824
    s_add_u32 s60, s47, 8
    s_add_u32 s61, s60, s52
    s_lshl_b32 s54, s61, 14
    s_add_u32 s54, s54, 6291456
    s_lshl_b32 s59, s61, 10
    s_cmp_lt_u32 s60, s20
    s_cselect_b32 s54, s54, 1073741824
    s_cselect_b32 s59, s59, 1073741824
    s_add_u32 s60, s50, 0
    s_and_b32 s60, s60, 3
    s_lshl_b32 s60, s60, 12
    v_add_u32 v96, s60, v9
    s_add_u32 s60, s50, 1
    s_and_b32 s60, s60, 3
    s_lshl_b32 s60, s60, 12
    v_add_u32 v97, s60, v9
    s_add_u32 s60, s50, 2
    s_and_b32 s60, s60, 3
    s_lshl_b32 s60, s60, 12
    v_add_u32 v98, s60, v9
    s_add_u32 s60, s50, 3
    s_and_b32 s60, s60, 3
    s_lshl_b32 s60, s60, 12
    v_add_u32 v99, s60, v9
    s_lshr_b32 s60, s52, 2
    s_lshl_b32 s60, s60, 3
    s_add_u32 s61, s52, s20
    s_sub_u32 s61, s61, 1
    s_lshr_b32 s61, s61, 2
    s_lshl_b32 s61, s61, 3
    s_add_u32 s61, s61, 7
    v_add_u32 v20, s60, v1
    v_min_u32 v20, s61, v20
    v_lshlrev_b32 v20, 7, v20
    v_lshlrev_b32 v27, 3, v6
    s_lshl_b32 s60, s47, 11
    s_add_u32 s60, s60, 109056
    v_lshlrev_b32 v28, 7, v6
    v_lshl_add_u32 v28, v7, 4, v28
    v_add_u32 v28, s60, v28
    s_mov_b32 s57, 17039360
    s_cmp_eq_u32 s47, 0
    s_cselect_b32 s57, s57, 1073741824
    ds_read_b32 v30, v5 offset:12
    s_setprio 3
    s_mov_b32 s63, 0
.ss_54:
    ds_read_b32 v24, v5 offset:64
    s_add_u32 s63, s63, 1
    s_cmp_gt_u32 s63, 262144
    s_cbranch_scc1 .ssx_55
    s_waitcnt lgkmcnt(0)
    v_cmp_gt_u32 vcc, 4, v24
    s_sleep 1
    s_cbranch_vccnz .ss_54
.ssx_55:
    s_add_u32 m0, s68, 117248
    s_nop 0
    buffer_load_dwordx4 v15, s[28:31], s69 offen nt lds
    s_add_u32 m0, s68, 118272
    s_add_u32 s69, s69, 49152
    buffer_load_dwordx4 v15, s[28:31], s69 offen nt lds
    s_add_u32 m0, s68, 119296
    s_add_u32 s69, s69, 49152
    buffer_load_dwordx4 v15, s[28:31], s69 offen nt lds
    s_add_u32 m0, s68, 120320
    s_add_u32 s69, s69, 49152
    buffer_load_dwordx4 v15, s[28:31], s69 offen nt lds
    s_lshl_b32 s64, s47, 11
    s_add_u32 m0, s64, 109056
    s_nop 0
    buffer_load_dwordx4 v3, s[36:39], s12 offen nt lds
    s_add_u32 m0, s64, 110080
    s_add_u32 s12, s12, 0x2000
    buffer_load_dwordx4 v3, s[36:39], s12 offen nt lds
    s_waitcnt vmcnt(2) lgkmcnt(0)
    v_mov_b32 v24, 1
    s_mov_b64 exec, 1
    ds_add_u32 v5, v24 offset:40
    s_mov_b64 exec, -1
    v_readfirstlane_b32 s51, v30
    s_lshr_b32 s51, s51, 1
    s_waitcnt vmcnt(0)
    ds_read_b128 v[40:43], v28
    ds_read_b128 v[44:47], v28 offset:64
    s_mov_b32 s60, 0x3f803f80
    v_mov_b32 v80, s60
    v_mov_b32 v81, s60
    v_mov_b32 v82, s60
    v_mov_b32 v83, s60
    v_and_b32 v14, 3, v1
    v_cmp_eq_u32 s[64:65], 1, v14
    v_cmp_eq_u32 s[66:67], 2, v14
    v_cmp_eq_u32 s[68:69], 3, v14
    v_bfe_u32 v14, v1, 2, 2
    v_cmp_eq_u32 s[70:71], v14, v7
    s_waitcnt lgkmcnt(0)
    v_mfma_f32_16x16x32_bf16 v[72:75], v[40:43], v[40:43], 0
    v_mfma_f32_16x16x32_bf16 v[76:79], v[80:83], v[40:43], 0
    v_mfma_f32_16x16x32_bf16 v[72:75], v[44:47], v[44:47], v[72:75]
    v_mfma_f32_16x16x32_bf16 v[76:79], v[80:83], v[44:47], v[76:79]
    s_lshl_b32 s60, s2, 10
    s_lshl_b32 s61, s47, 8
    s_add_u32 s60, s60, s61
    s_add_u32 s60, s60, 17203200
    v_lshlrev_b32 v14, 4, v6
    s_nop 1
    v_cndmask_b32 v72, v72, v73, s[64:65]
    v_cndmask_b32 v72, v72, v74, s[66:67]
    v_cndmask_b32 v77, v72, v75, s[68:69]
    v_mov_b32 v78, s62
    v_mov_b32 v79, s62
    s_mov_b64 exec, s[70:71]
    s_cmp_eq_u32 s51, 0
    s_cbranch_scc1 .slow_56
    buffer_store_dwordx4 v[76:79], v14, s[40:43], s60 offen
    s_branch .pubd_57
.slow_56:
    buffer_store_dwordx4 v[76:79], v14, s[40:43], s60 offen sc1
.pubd_57:
    s_mov_b64 exec, -1
    s_mov_b32 s63, 0
.ss_58:
    ds_read_b32 v24, v5 offset:40
    s_add_u32 s63, s63, 1
    s_cmp_gt_u32 s63, 262144
    s_cbranch_scc1 .ssx_59
    s_waitcnt lgkmcnt(0)
    v_cmp_gt_u32 vcc, 4, v24
    s_cbranch_vccnz .ss_58
.ssx_59:
    ds_read_b128 v[40:43], v23 offset:3456
    ds_read_b64_tr_b16 v[56:57], v22 offset:0
    ds_read_b64_tr_b16 v[58:59], v22 offset:512
    ds_read_b128 v[44:47], v23 offset:3520
    ds_read_b64_tr_b16 v[60:61], v22 offset:4096
    ds_read_b64_tr_b16 v[62:63], v22 offset:4608
    ds_read_b128 v[48:51], v23 offset:3584
    ds_read_b64_tr_b16 v[64:65], v22 offset:8192
    ds_read_b64_tr_b16 v[66:67], v22 offset:8704
    ds_read_b128 v[52:55], v23 offset:3648
    ds_read_b64_tr_b16 v[68:69], v22 offset:12288
    ds_read_b64_tr_b16 v[70:71], v22 offset:12800
    s_waitcnt lgkmcnt(9)
    v_mfma_f32_16x16x32_bf16 v[80:83], v[40:43], v[56:59], 0
    s_waitcnt lgkmcnt(6)
    v_mfma_f32_16x16x32_bf16 v[80:83], v[44:47], v[60:63], v[80:83]
    s_waitcnt lgkmcnt(3)
    v_mfma_f32_16x16x32_bf16 v[80:83], v[48:51], v[64:67], v[80:83]
    s_waitcnt lgkmcnt(0)
    v_mfma_f32_16x16x32_bf16 v[80:83], v[52:55], v[68:71], v[80:83]
    s_nop 7
    v_mov_b32 v81, s62
    s_mov_b64 exec, 0xffff
    buffer_store_dwordx2 v[80:81], v27, s[40:43], s22 offen sc1
    s_mov_b64 exec, -1
    buffer_load_dword v31, v20, s[40:43], s57 offen sc1
    s_mov_b32 s63, 0
.ss_60:
    ds_read_b32 v24, v5 offset:8
    s_add_u32 s63, s63, 1
    s_cmp_gt_u32 s63, 262144
    s_cbranch_scc1 .ssx_61
    s_waitcnt lgkmcnt(0)
    v_cmp_gt_u32 vcc, 4, v24
    s_sleep 1
    s_cbranch_vccnz .ss_60
.ssx_61:
    s_lshl_b32 s60, s47, 11
    s_add_u32 m0, s60, 100864
    s_nop 0
    buffer_load_dwordx4 v12, s[32:35], s13 offen nt lds
    s_add_u32 m0, s60, 101888
    s_add_u32 s13, s13, 0x4000
    buffer_load_dwordx4 v12, s[32:35], s13 offen nt lds
    v_lshlrev_b32 v26, 7, v6
    s_mul_i32 s70, s49, 196608
    s_lshl_b32 s71, s48, 13
    s_add_u32 s70, s70, s71
    s_lshl_b32 s71, s47, 11
    s_add_u32 s70, s70, s71
    s_add_u32 s70, s70, 65536
    buffer_load_dword v250, v26, s[40:43], s70 offen sc1
    s_cmp_lg_u32 s47, 0
    s_cbranch_scc1 .np_63
    s_waitcnt vmcnt(3)
    v_cmp_ne_u32 vcc, s62, v31
    s_cbranch_vccz .f3a_62
    s_mov_b32 s63, 0
.poll_65:
    buffer_load_dword v31, v20, s[40:43], s57 offen sc1
    s_add_u32 s63, s63, 1
    s_cmp_gt_u32 s63, 262144
    s_cbranch_scc1 .pollx_66
    s_waitcnt vmcnt(0)
    v_cmp_ne_u32 vcc, s62, v31
    s_cbranch_vccz .pollx_66
    s_sleep 2
    s_branch .poll_65
.pollx_66:
.f3a_62:
    v_mov_b32 v24, 1
    s_mov_b64 exec, 1
    ds_add_u32 v5, v24 offset:32
    s_mov_b64 exec, -1
    s_branch .pj_64
.np_63:
    s_mov_b32 s63, 0
.ss_67:
    ds_read_b32 v24, v5 offset:32
    s_add_u32 s63, s63, 1
    s_cmp_gt_u32 s63, 262144
    s_cbranch_scc1 .ssx_68
    s_waitcnt lgkmcnt(0)
    v_cmp_gt_u32 vcc, 1, v24
    s_sleep 1
    s_cbranch_vccnz .ss_67
.ssx_68:
.pj_64:
    buffer_load_dwordx4 v[224:227], v96, s[40:43], s53 offen offset:0 sc1
    buffer_load_dwordx4 v[228:231], v96, s[40:43], s54 offen offset:0 sc1
    buffer_load_dwordx4 v[216:219], v96, s[40:43], s53 offen offset:1024 sc1
    buffer_load_dwordx4 v[220:223], v96, s[40:43], s54 offen offset:1024 sc1
    buffer_load_dwordx4 v[208:211], v97, s[40:43], s53 offen offset:0 sc1
    buffer_load_dwordx4 v[212:215], v97, s[40:43], s54 offen offset:0 sc1
    buffer_load_dwordx4 v[200:203], v98, s[40:43], s53 offen offset:0 sc1
    buffer_load_dwordx4 v[204:207], v98, s[40:43], s54 offen offset:0 sc1
    s_waitcnt vmcnt(9)
    ds_read_b64_tr_b16 v[32:33], v18
    ds_read_b64_tr_b16 v[34:35], v18 offset:256
    ds_read_b64_tr_b16 v[36:37], v18 offset:1024
    ds_read_b64_tr_b16 v[38:39], v18 offset:1280
    s_waitcnt lgkmcnt(0)
    buffer_store_dwordx4 v[32:35], v9, s[40:43], s56 offen sc1
    buffer_store_dwordx4 v[36:39], v9, s[40:43], s56 offen offset:1024 sc1
    buffer_load_dwordx4 v[192:195], v99, s[40:43], s53 offen offset:0 sc1
    buffer_load_dwordx4 v[196:199], v99, s[40:43], s54 offen offset:0 sc1
    buffer_load_dwordx4 v[184:187], v96, s[40:43], s53 offen offset:2048 sc1
    buffer_load_dwordx4 v[188:191], v96, s[40:43], s54 offen offset:2048 sc1
    buffer_load_dwordx4 v[176:179], v97, s[40:43], s53 offen offset:1024 sc1
    buffer_load_dwordx4 v[180:183], v97, s[40:43], s54 offen offset:1024 sc1
    s_waitcnt vmcnt(6)
    v_mov_b32 v24, 1
    s_mov_b64 exec, 1
    ds_add_rtn_u32 v24, v5, v24 offset:28
    s_mov_b64 exec, -1
    s_waitcnt lgkmcnt(0)
    v_readfirstlane_b32 s63, v24
    s_cmp_eq_u32 s63, 3
    s_cselect_b32 s23, s23, 1073741824
    buffer_store_dword v19, v5, s[40:43], s23 offen sc1
    s_setprio 0
    buffer_load_dwordx4 v[168:171], v98, s[40:43], s53 offen offset:1024 sc1
    buffer_load_dwordx4 v[172:175], v98, s[40:43], s54 offen offset:1024 sc1
    buffer_load_dwordx4 v[160:163], v99, s[40:43], s53 offen offset:1024 sc1
    buffer_load_dwordx4 v[164:167], v99, s[40:43], s54 offen offset:1024 sc1
    buffer_load_dwordx4 v[152:155], v96, s[40:43], s53 offen offset:3072 sc1
    buffer_load_dwordx4 v[156:159], v96, s[40:43], s54 offen offset:3072 sc1
    buffer_load_dwordx4 v[144:147], v97, s[40:43], s53 offen offset:2048 sc1
    buffer_load_dwordx4 v[148:151], v97, s[40:43], s54 offen offset:2048 sc1
    buffer_load_dwordx4 v[136:139], v98, s[40:43], s53 offen offset:2048 sc1
    buffer_load_dwordx4 v[140:143], v98, s[40:43], s54 offen offset:2048 sc1
    buffer_load_dwordx4 v[128:131], v99, s[40:43], s53 offen offset:2048 sc1
    buffer_load_dwordx4 v[132:135], v99, s[40:43], s54 offen offset:2048 sc1
    buffer_load_dwordx4 v[120:123], v97, s[40:43], s53 offen offset:3072 sc1
    buffer_load_dwordx4 v[124:127], v97, s[40:43], s54 offen offset:3072 sc1
    buffer_load_dwordx4 v[112:115], v98, s[40:43], s53 offen offset:3072 sc1
    buffer_load_dwordx4 v[116:119], v98, s[40:43], s54 offen offset:3072 sc1
    buffer_load_dwordx4 v[104:107], v99, s[40:43], s53 offen offset:3072 sc1
    buffer_load_dwordx4 v[108:111], v99, s[40:43], s54 offen offset:3072 sc1
    s_mul_i32 s22, s50, 5
    s_mul_i32 s60, s48, 3
    s_add_u32 s22, s22, s60
    s_sub_u32 s60, s22, 22
    s_cmp_ge_u32 s22, 22
    s_cselect_b32 s22, s60, s22
    s_lshl_b32 s22, s22, 12
    s_cmp_ge_u32 s47, 2
    s_cselect_b32 s31, 1073741824, 86016
    s_cmp_eq_u32 s22, 86016
    s_cselect_b32 s78, s31, s22
    s_cselect_b32 s22, 4294963200, s22
    s_add_u32 s22, s22, 4096
    s_cmp_eq_u32 s22, 86016
    s_cselect_b32 s79, s31, s22
    s_cselect_b32 s22, 4294963200, s22
    s_add_u32 s22, s22, 4096
    s_cmp_eq_u32 s22, 86016
    s_cselect_b32 s80, s31, s22
    s_cselect_b32 s22, 4294963200, s22
    s_add_u32 s22, s22, 4096
    s_cmp_eq_u32 s22, 86016
    s_cselect_b32 s81, s31, s22
    s_cselect_b32 s22, 4294963200, s22
    s_add_u32 s22, s22, 4096
    s_cmp_eq_u32 s22, 86016
    s_cselect_b32 s82, s31, s22
    s_cselect_b32 s22, 4294963200, s22
    s_add_u32 s22, s22, 4096
    s_cmp_eq_u32 s22, 86016
    s_cselect_b32 s83, s31, s22
    s_cselect_b32 s22, 4294963200, s22
    s_add_u32 s22, s22, 4096
    s_cmp_eq_u32 s22, 86016
    s_cselect_b32 s84, s31, s22
    s_cselect_b32 s22, 4294963200, s22
    s_add_u32 s22, s22, 4096
    s_cmp_eq_u32 s22, 86016
    s_cselect_b32 s85, s31, s22
    s_cselect_b32 s22, 4294963200, s22
    s_add_u32 s22, s22, 4096
    s_cmp_eq_u32 s22, 86016
    s_cselect_b32 s86, s31, s22
    s_cselect_b32 s22, 4294963200, s22
    s_add_u32 s22, s22, 4096
    s_cmp_eq_u32 s22, 86016
    s_cselect_b32 s87, s31, s22
    s_cselect_b32 s22, 4294963200, s22
    s_add_u32 s22, s22, 4096
    s_cmp_eq_u32 s22, 86016
    s_cselect_b32 s88, s31, s22
    s_cselect_b32 s22, 4294963200, s22
    s_add_u32 s22, s22, 4096
    s_cmp_eq_u32 s22, 86016
    s_cselect_b32 s89, s31, s22
    s_cselect_b32 s22, 4294963200, s22
    s_add_u32 s22, s22, 4096
    s_cmp_eq_u32 s22, 86016
    s_cselect_b32 s90, s31, s22
    s_cselect_b32 s22, 4294963200, s22
    s_add_u32 s22, s22, 4096
    s_cmp_eq_u32 s22, 86016
    s_cselect_b32 s91, s31, s22
    s_cselect_b32 s22, 4294963200, s22
    s_add_u32 s22, s22, 4096
    s_cmp_eq_u32 s22, 86016
    s_cselect_b32 s92, s31, s22
    s_cselect_b32 s22, 4294963200, s22
    s_add_u32 s22, s22, 4096
    s_cmp_eq_u32 s22, 86016
    s_cselect_b32 s93, s31, s22
    s_cselect_b32 s22, 4294963200, s22
    s_add_u32 s22, s22, 4096
    s_cmp_eq_u32 s22, 86016
    s_cselect_b32 s94, s31, s22
    s_cselect_b32 s22, 4294963200, s22
    s_add_u32 s22, s22, 4096
    s_cmp_eq_u32 s22, 86016
    s_cselect_b32 s95, s31, s22
    s_cselect_b32 s22, 4294963200, s22
    s_add_u32 s22, s22, 4096
    s_cmp_eq_u32 s22, 86016
    s_cselect_b32 s96, s31, s22
    s_cselect_b32 s22, 4294963200, s22
    s_add_u32 s22, s22, 4096
    s_cmp_eq_u32 s22, 86016
    s_cselect_b32 s97, s31, s22
    s_cselect_b32 s22, 4294963200, s22
    s_add_u32 s22, s22, 4096
    s_cmp_eq_u32 s22, 86016
    s_cselect_b32 s98, s31, s22
    s_cselect_b32 s22, 4294963200, s22
    s_add_u32 s22, s22, 4096
    s_cmp_eq_u32 s22, 86016
    s_cselect_b32 s99, s31, s22
    s_cselect_b32 s22, 4294963200, s22
    s_add_u32 s22, s22, 4096
    s_lshr_b32 s33, s46, 2
    s_lshl_b32 s27, s48, 1
    s_add_u32 s27, s27, s33
    s_xor_b32 s61, s27, 1
    s_mul_i32 s27, s27, 88064
    s_mul_i32 s61, s61, 88064
    s_lshl_b32 s60, s47, 10
    s_add_u32 s60, s60, 8388608
    s_add_u32 s27, s27, s60
    s_add_u32 s61, s61, s60
    s_and_b32 s60, s46, 1
    s_lshl_b32 s60, s60, 8
    v_xor_b32 v15, s60, v9
    v_add_u32 v36, s61, v15
    v_add_u32 v15, s27, v15
    v_min_u32 v90, 42, v1
    v_lshlrev_b32 v90, 9, v90
    s_lshr_b32 s57, s48, 1
    s_lshl_b32 s57, s57, 7
    s_add_u32 s57, s57, 17072128
    s_cmp_eq_u32 s47, 0
    s_cselect_b32 s57, s57, 1073741824
    v_and_b32 v13, 3, v1
    v_lshrrev_b32 v11, 5, v1
    v_lshl_add_u32 v12, v11, 2, v13
    s_lshl_b32 s60, s46, 3
    v_add_u32 v12, s60, v12
    v_bfe_u32 v16, v1, 2, 3
    v_lshlrev_b32 v18, 7, v12
    v_lshl_add_u32 v18, v16, 4, v18
    s_mul_i32 s29, s49, 196608
    s_lshl_b32 s60, s48, 13
    s_add_u32 s28, s29, s60
    s_add_u32 s29, s29, 65536
    s_add_u32 s30, s29, s60
    s_lshl_b32 s60, s33, 12
    s_add_u32 s30, s30, s60
    s_lshl_b32 s60, s47, 8
    s_add_u32 s30, s30, s60
    s_lshl_b32 s60, s46, 3
    v_add_u32 v19, s60, v4
    v_lshrrev_b32 v2, 1, v19
    v_lshlrev_b32 v2, 12, v2
    v_and_b32 v19, 1, v1
    v_lshl_add_u32 v19, v19, 8, v2
    s_lshl_b32 s32, s48, 9
    s_lshr_b32 s60, s49, 4
    s_lshl_b32 s60, s60, 7
    s_add_u32 s32, s32, s60
    s_add_u32 s32, s32, 16908288
    v_and_b32 v2, 1, v7
    v_lshl_add_u32 v2, v2, 2, v13
    v_lshlrev_b32 v2, 3, v2
    v_bfe_u32 v3, v1, 2, 2
    v_add_u32 v2, v2, v3
    v_lshlrev_b32 v2, 7, v2
    v_lshl_add_u32 v2, v11, 3, v2
    s_lshl_b32 s60, s46, 4
    s_add_u32 s60, s60, 109056
    v_add_u32 v2, s60, v2
    v_lshlrev_b32 v10, 7, v3
    v_lshl_add_u32 v10, v7, 5, v10
    v_lshl_add_u32 v10, v13, 3, v10
    s_lshl_b32 s60, s46, 10
    s_add_u32 s60, s60, 58880
    v_add_u32 v10, s60, v10
    v_lshlrev_b32 v37, 10, v7
    v_lshl_add_u32 v37, v6, 4, v37
    v_lshlrev_b32 v3, 5, v16
    v_lshlrev_b32 v12, 5, v12
    s_lshl_b32 s34, s2, 7
    s_and_b32 s36, s2, 0xc7
    s_lshl_b32 s36, s36, 7
    s_lshl_b32 s38, s49, 12
    s_lshl_b32 s60, s46, 9
    s_add_u32 s38, s38, s60
    s_add_u32 s38, s38, 17829888
    v_lshlrev_b32 v8, 10, v4
    v_mov_b32 v39, s62
    s_lshl_b32 s60, s47, 10
    s_add_u32 s29, s29, s60
    s_lshl_b32 s61, s33, 12
    s_add_u32 s52, s60, s61
    s_add_u32 s37, s36, 17104896
    s_add_u32 s60, s50, 0
    s_and_b32 s60, s60, 3
    s_lshl_b32 s60, s60, 14
    s_add_u32 s4, s60, s29
    s_add_u32 s60, s50, 1
    s_and_b32 s60, s60, 3
    s_lshl_b32 s60, s60, 14
    s_add_u32 s5, s60, s29
    s_add_u32 s60, s50, 2
    s_and_b32 s60, s60, 3
    s_lshl_b32 s60, s60, 14
    s_add_u32 s6, s60, s29
    s_add_u32 s60, s50, 3
    s_and_b32 s60, s60, 3
    s_lshl_b32 s60, s60, 14
    s_add_u32 s7, s60, s29
    s_add_u32 s8, s4, 4096
    s_add_u32 s9, s6, 0
    s_add_u32 s10, s4, 8192
    s_add_u32 s11, s6, 4096
    s_add_u32 s12, s4, 12288
    s_add_u32 s13, s6, 8192
    s_add_u32 s14, s5, 12288
    s_add_u32 s15, s7, 12288
    s_mov_b32 s63, 0
.ss_69:
    ds_read_b32 v88, v5 offset:44
    s_add_u32 s63, s63, 1
    s_cmp_gt_u32 s63, 262144
    s_cbranch_scc1 .ssx_70
    s_waitcnt lgkmcnt(0)
    v_cmp_gt_u32 vcc, 4, v88
    s_sleep 1
    s_cbranch_vccnz .ss_69
.ssx_70:
    v_lshlrev_b32 v92, 3, v1
    buffer_load_dword v88, v19, s[40:43], s32 offen sc1
    buffer_load_dwordx2 v[94:95], v92, s[40:43], s38 offen sc1
    buffer_load_dword v89, v90, s[40:43], s57 offen sc1
    ds_read_b64_tr_b16 v[56:57], v2
    ds_read_b64_tr_b16 v[58:59], v2 offset:512
    ds_read_b128 v[60:63], v12 offset:1408
    ds_read_b128 v[64:67], v3 offset:128
    ds_read_b128 v[68:71], v3 offset:144
    ds_read_b128 v[72:75], v3 offset:384
    ds_read_b128 v[76:79], v3 offset:400
    ds_read_b32 v91, v5 offset:12
    s_lshl_b32 s60, s46, 7
    v_lshl_add_u32 v93, v1, 1, s60
    s_add_u32 s35, s34, 17104896
    s_waitcnt lgkmcnt(5)
    v_lshlrev_b32 v40, 16, v56
    v_and_b32 v41, 0xffff0000, v56
    v_lshlrev_b32 v42, 16, v57
    v_and_b32 v43, 0xffff0000, v57
    v_lshlrev_b32 v44, 16, v58
    v_and_b32 v45, 0xffff0000, v58
    v_lshlrev_b32 v46, 16, v59
    v_and_b32 v47, 0xffff0000, v59
    v_add_f32 v61, 1.0, v61
    v_add_f32 v63, 1.0, v63
    v_cvt_pk_bf16_f32 v56, v61, v63
    v_lshlrev_b32 v61, 16, v56
    v_and_b32 v82, 0xffff0000, v56
    v_mul_f32 v80, v62, v61
    v_mul_f32 v81, v62, v60
    s_waitcnt lgkmcnt(0)
    v_readfirstlane_b32 s51, v91
    s_lshr_b32 s51, s51, 1
    s_lshl_b32 s60, s51, 26
    s_xor_b32 s60, s60, s62
    v_mov_b32 v17, s60
    v_pk_add_f32 v[48:49], v[40:41], v[64:65] neg_lo:[0,1] neg_hi:[0,1]
    v_pk_add_f32 v[50:51], v[42:43], v[66:67] neg_lo:[0,1] neg_hi:[0,1]
    v_pk_add_f32 v[52:53], v[44:45], v[68:69] neg_lo:[0,1] neg_hi:[0,1]
    v_pk_add_f32 v[54:55], v[46:47], v[70:71] neg_lo:[0,1] neg_hi:[0,1]
    v_pk_mul_f32 v[72:73], v[72:73], v[80:81] op_sel_hi:[1,0]
    v_pk_mul_f32 v[74:75], v[74:75], v[80:81] op_sel_hi:[1,0]
    v_pk_mul_f32 v[76:77], v[76:77], v[80:81] op_sel_hi:[1,0]
    v_pk_mul_f32 v[78:79], v[78:79], v[80:81] op_sel_hi:[1,0]
    v_pk_fma_f32 v[48:49], v[48:49], v[72:73], v[80:81] op_sel:[0,0,1] op_sel_hi:[1,1,1]
    v_pk_fma_f32 v[50:51], v[50:51], v[74:75], v[80:81] op_sel:[0,0,1] op_sel_hi:[1,1,1]
    v_pk_fma_f32 v[52:53], v[52:53], v[76:77], v[80:81] op_sel:[0,0,1] op_sel_hi:[1,1,1]
    v_pk_fma_f32 v[54:55], v[54:55], v[78:79], v[80:81] op_sel:[0,0,1] op_sel_hi:[1,1,1]
    s_waitcnt vmcnt(0)
    v_cmp_ne_u32 vcc, s62, v88
    s_cbranch_vccz .f4ok_71
    s_mov_b32 s63, 0
.poll_72:
    buffer_load_dword v88, v19, s[40:43], s32 offen sc1
    s_add_u32 s63, s63, 1
    s_cmp_gt_u32 s63, 262144
    s_cbranch_scc1 .pollx_73
    s_waitcnt vmcnt(0)
    v_cmp_ne_u32 vcc, s62, v88
    s_cbranch_vccz .pollx_73
    s_sleep 2
    s_branch .poll_72
.pollx_73:
.f4ok_71:
    buffer_load_dwordx4 v[56:59], v18, s[40:43], s28 offen sc1
    v_cmp_ne_u32 vcc, s62, v95
    s_cbranch_vccz .a2ok_74
    s_mov_b32 s63, 0
.poll_75:
    buffer_load_dwordx2 v[94:95], v92, s[40:43], s38 offen sc1
    s_add_u32 s63, s63, 1
    s_cmp_gt_u32 s63, 262144
    s_cbranch_scc1 .pollx_76
    s_waitcnt vmcnt(0)
    v_cmp_ne_u32 vcc, s62, v95
    s_cbranch_vccz .pollx_76
    s_sleep 1
    s_branch .poll_75
.pollx_76:
.a2ok_74:
    ds_write_b16 v93, v94 offset:3712
    ds_write_b16 v93, v94 offset:4736
    ds_write_b16_d16_hi v93, v94 offset:5824
    ds_write_b16_d16_hi v93, v94 offset:6848
    s_waitcnt vmcnt(0)
    v_lshlrev_b32 v60, 16, v56
    v_and_b32 v61, 0xffff0000, v56
    v_lshlrev_b32 v62, 16, v57
    v_and_b32 v63, 0xffff0000, v57
    v_lshlrev_b32 v64, 16, v58
    v_and_b32 v65, 0xffff0000, v58
    v_lshlrev_b32 v66, 16, v59
    v_and_b32 v67, 0xffff0000, v59
    v_pk_fma_f32 v[40:41], v[48:49], v[60:61], v[40:41]
    v_pk_fma_f32 v[42:43], v[50:51], v[62:63], v[42:43]
    v_pk_fma_f32 v[44:45], v[52:53], v[64:65], v[44:45]
    v_pk_fma_f32 v[46:47], v[54:55], v[66:67], v[46:47]
    v_pk_mul_f32 v[60:61], v[40:41], v[82:83] op_sel_hi:[1,0]
    v_pk_mul_f32 v[62:63], v[42:43], v[82:83] op_sel_hi:[1,0]
    v_pk_mul_f32 v[64:65], v[44:45], v[82:83] op_sel_hi:[1,0]
    v_pk_mul_f32 v[66:67], v[46:47], v[82:83] op_sel_hi:[1,0]
    v_cvt_pk_bf16_f32 v68, v60, v61
    v_cvt_pk_bf16_f32 v69, v62, v63
    v_cvt_pk_bf16_f32 v70, v64, v65
    v_cvt_pk_bf16_f32 v71, v66, v67
    ds_write_b128 v18, v[68:71] offset:58880
    ds_read_b64_tr_b16 v[72:73], v10
    ds_read_b64_tr_b16 v[74:75], v10 offset:512
    v_cvt_pk_bf16_f32 v56, v40, v41
    v_cvt_pk_bf16_f32 v57, v42, v43
    v_cvt_pk_bf16_f32 v58, v44, v45
    v_cvt_pk_bf16_f32 v59, v46, v47
    ds_write_b128 v18, v[56:59] offset:8192
    s_waitcnt lgkmcnt(1)
    buffer_store_dwordx4 v[72:75], v37, s[40:43], s30 offen
    v_and_b32 v2, 1, v1
    v_mul_u32_u24 v2, 2112, v2
    v_lshl_add_u32 v2, v7, 4, v2
    s_lshl_b32 s60, s50, 8
    v_add_u32 v2, s60, v2
    s_lshl_b32 s60, s47, 10
    v_add_u32 v3, 16384, v9
    s_waitcnt vmcnt(0) lgkmcnt(0)
    v_mov_b32 v88, 1
    s_mov_b64 exec, 1
    ds_add_rtn_u32 v88, v5, v88 offset:48
    s_mov_b64 exec, -1
    s_waitcnt lgkmcnt(0)
    v_readfirstlane_b32 s63, v88
    s_cmp_eq_u32 s63, 7
    s_cselect_b32 s35, s35, 1073741824
    s_cmp_eq_u32 s51, 0
    s_cbranch_scc1 .slow_77
    buffer_store_dword v17, v5, s[40:43], s35 offen
    s_branch .pubd_78
.slow_77:
    buffer_wbl2 sc1
    s_waitcnt vmcnt(0)
    buffer_store_dword v17, v5, s[40:43], s35 offen sc1
.pubd_78:
    s_xor_b32 s61, s60, 0
    v_add_u32 v10, s61, v3
    s_xor_b32 s61, s60, 1024
    v_add_u32 v18, s61, v3
    s_xor_b32 s61, s60, 2048
    v_add_u32 v19, s61, v3
    s_xor_b32 s61, s60, 3072
    v_add_u32 v37, s61, v3
    s_cmp_lg_u32 s47, 0
    s_cbranch_scc1 .np_80
    v_cmp_ne_u32 vcc, s62, v89
    s_cbranch_vccz .f3b_79
    s_mov_b32 s63, 0
.poll_81:
    buffer_load_dword v89, v90, s[40:43], s57 offen sc1
    s_add_u32 s63, s63, 1
    s_cmp_gt_u32 s63, 262144
    s_cbranch_scc1 .pollx_82
    s_waitcnt vmcnt(0)
    v_cmp_ne_u32 vcc, s62, v89
    s_cbranch_vccz .pollx_82
    s_sleep 2
    s_branch .poll_81
.pollx_82:
.f3b_79:
.np_80:
    s_mov_b32 s63, 0
.ss_83:
    ds_read_b32 v88, v5 offset:48
    s_add_u32 s63, s63, 1
    s_cmp_gt_u32 s63, 262144
    s_cbranch_scc1 .ssx_84
    s_waitcnt lgkmcnt(0)
    v_cmp_gt_u32 vcc, 8, v88
    s_cbranch_vccnz .ss_83
.ssx_84:
    buffer_load_dword v88, v8, s[40:43], s37 offen sc1
    ds_read_b128 v[56:59], v2 offset:3712
    ds_read_b128 v[60:63], v2 offset:3776
    ds_read_b128 v[64:67], v2 offset:3968
    ds_read_b128 v[68:71], v2 offset:4224
    s_waitcnt lgkmcnt(3)
    v_mfma_f32_16x16x32_bf16 v[28:31], v[224:227], v[56:59], 0
    v_mfma_f32_16x16x32_bf16 v[32:35], v[228:231], v[56:59], 0
    ds_read_b128 v[56:59], v2 offset:4480
    s_waitcnt lgkmcnt(3)
    v_mfma_f32_16x16x32_bf16 v[28:31], v[216:219], v[60:63], v[28:31]
    v_mfma_f32_16x16x32_bf16 v[32:35], v[220:223], v[60:63], v[32:35]
    ds_read_b128 v[60:63], v2 offset:3840
    s_waitcnt lgkmcnt(3)
    v_mfma_f32_16x16x32_bf16 v[28:31], v[208:211], v[64:67], v[28:31]
    v_mfma_f32_16x16x32_bf16 v[32:35], v[212:215], v[64:67], v[32:35]
    ds_read_b128 v[64:67], v2 offset:4032
    s_waitcnt lgkmcnt(3)
    v_mfma_f32_16x16x32_bf16 v[28:31], v[200:203], v[68:71], v[28:31]
    v_mfma_f32_16x16x32_bf16 v[32:35], v[204:207], v[68:71], v[32:35]
    ds_read_b128 v[68:71], v2 offset:4288
    s_waitcnt lgkmcnt(3)
    v_mfma_f32_16x16x32_bf16 v[28:31], v[192:195], v[56:59], v[28:31]
    v_mfma_f32_16x16x32_bf16 v[32:35], v[196:199], v[56:59], v[32:35]
    ds_read_b128 v[56:59], v2 offset:4544
    s_waitcnt lgkmcnt(3)
    v_mfma_f32_16x16x32_bf16 v[28:31], v[184:187], v[60:63], v[28:31]
    v_mfma_f32_16x16x32_bf16 v[32:35], v[188:191], v[60:63], v[32:35]
    ds_read_b128 v[60:63], v2 offset:3904
    s_waitcnt lgkmcnt(3)
    v_mfma_f32_16x16x32_bf16 v[28:31], v[176:179], v[64:67], v[28:31]
    v_mfma_f32_16x16x32_bf16 v[32:35], v[180:183], v[64:67], v[32:35]
    ds_read_b128 v[64:67], v2 offset:4096
    s_waitcnt lgkmcnt(3)
    v_mfma_f32_16x16x32_bf16 v[28:31], v[168:171], v[68:71], v[28:31]
    v_mfma_f32_16x16x32_bf16 v[32:35], v[172:175], v[68:71], v[32:35]
    ds_read_b128 v[68:71], v2 offset:4352
    s_waitcnt lgkmcnt(3)
    v_mfma_f32_16x16x32_bf16 v[28:31], v[160:163], v[56:59], v[28:31]
    v_mfma_f32_16x16x32_bf16 v[32:35], v[164:167], v[56:59], v[32:35]
    ds_read_b128 v[56:59], v2 offset:4608
    s_waitcnt lgkmcnt(3)
    v_mfma_f32_16x16x32_bf16 v[28:31], v[152:155], v[60:63], v[28:31]
    v_mfma_f32_16x16x32_bf16 v[32:35], v[156:159], v[60:63], v[32:35]
    ds_read_b128 v[60:63], v2 offset:4160
    s_waitcnt lgkmcnt(3)
    v_mfma_f32_16x16x32_bf16 v[28:31], v[144:147], v[64:67], v[28:31]
    v_mfma_f32_16x16x32_bf16 v[32:35], v[148:151], v[64:67], v[32:35]
    ds_read_b128 v[64:67], v2 offset:4416
    s_waitcnt lgkmcnt(3)
    v_mfma_f32_16x16x32_bf16 v[28:31], v[136:139], v[68:71], v[28:31]
    v_mfma_f32_16x16x32_bf16 v[32:35], v[140:143], v[68:71], v[32:35]
    ds_read_b128 v[68:71], v2 offset:4672
    s_waitcnt lgkmcnt(3)
    v_mfma_f32_16x16x32_bf16 v[28:31], v[128:131], v[56:59], v[28:31]
    v_mfma_f32_16x16x32_bf16 v[32:35], v[132:135], v[56:59], v[32:35]
    s_waitcnt lgkmcnt(2)
    v_mfma_f32_16x16x32_bf16 v[28:31], v[120:123], v[60:63], v[28:31]
    v_mfma_f32_16x16x32_bf16 v[32:35], v[124:127], v[60:63], v[32:35]
    s_waitcnt lgkmcnt(1)
    v_mfma_f32_16x16x32_bf16 v[28:31], v[112:115], v[64:67], v[28:31]
    v_mfma_f32_16x16x32_bf16 v[32:35], v[116:119], v[64:67], v[32:35]
    s_waitcnt lgkmcnt(0)
    v_mfma_f32_16x16x32_bf16 v[28:31], v[104:107], v[68:71], v[28:31]
    v_mfma_f32_16x16x32_bf16 v[32:35], v[108:111], v[68:71], v[32:35]
    s_mov_b32 s63, 0
    s_mov_b32 s60, 0xfbffffff
.f6_85:
    s_waitcnt vmcnt(0)
    v_xor_b32 v88, s62, v88
    v_and_b32 v89, s60, v88
    v_cmp_ne_u32 vcc, 0, v89
    s_cbranch_vccz .f6x_86
    s_add_u32 s63, s63, 1
    s_cmp_gt_u32 s63, 262144
    s_cbranch_scc1 .f6x_86
    s_sleep 1
    buffer_load_dword v88, v8, s[40:43], s37 offen sc1
    s_branch .f6_85
.f6x_86:
    s_add_u32 m0, s52, 16384
    s_nop 0
    buffer_load_dwordx4 v9, s[40:43], s8 offen sc1 lds
    s_add_u32 m0, s52, 24576
    s_nop 0
    buffer_load_dwordx4 v9, s[40:43], s9 offen sc1 lds
    s_mov_b32 s66, 0x55555555
    s_mov_b32 s67, 0x55555555
    v_mov_b32_dpp v62, v28 quad_perm:[1,0,3,2] row_mask:0xf bank_mask:0xf
    v_mov_b32_dpp v63, v29 quad_perm:[1,0,3,2] row_mask:0xf bank_mask:0xf
    v_mov_b32_dpp v64, v30 quad_perm:[1,0,3,2] row_mask:0xf bank_mask:0xf
    v_mov_b32_dpp v65, v31 quad_perm:[1,0,3,2] row_mask:0xf bank_mask:0xf
    v_cndmask_b32 v20, v62, v28, s[66:67]
    v_cndmask_b32 v28, v28, v62, s[66:67]
    v_cndmask_b32 v21, v63, v29, s[66:67]
    v_cndmask_b32 v29, v29, v63, s[66:67]
    v_cndmask_b32 v22, v64, v30, s[66:67]
    v_cndmask_b32 v30, v30, v64, s[66:67]
    v_cndmask_b32 v23, v65, v31, s[66:67]
    v_cndmask_b32 v31, v31, v65, s[66:67]
    v_mov_b32_dpp v62, v32 quad_perm:[1,0,3,2] row_mask:0xf bank_mask:0xf
    v_mov_b32_dpp v63, v33 quad_perm:[1,0,3,2] row_mask:0xf bank_mask:0xf
    v_mov_b32_dpp v64, v34 quad_perm:[1,0,3,2] row_mask:0xf bank_mask:0xf
    v_mov_b32_dpp v65, v35 quad_perm:[1,0,3,2] row_mask:0xf bank_mask:0xf
    v_cndmask_b32 v24, v62, v32, s[66:67]
    v_cndmask_b32 v32, v32, v62, s[66:67]
    v_cndmask_b32 v25, v63, v33, s[66:67]
    v_cndmask_b32 v33, v33, v63, s[66:67]
    v_cndmask_b32 v26, v64, v34, s[66:67]
    v_cndmask_b32 v34, v34, v64, s[66:67]
    v_cndmask_b32 v27, v65, v35, s[66:67]
    v_cndmask_b32 v35, v35, v65, s[66:67]
    s_and_b32 s30, s46, 1
    s_bfe_u32 s35, s46, 0x10001
    v_lshrrev_b32 v16, 5, v1
    v_bfe_u32 v11, v1, 2, 2
    v_lshl_add_u32 v11, v16, 2, v11
    v_lshlrev_b32 v11, 7, v11
    v_lshl_add_u32 v11, v13, 3, v11
    v_bfe_u32 v12, v1, 4, 1
    v_lshl_add_u32 v11, v12, 5, v11
    s_lshl_b32 s60, s33, 12
    s_lshl_b32 s61, s30, 11
    s_add_u32 s60, s60, s61
    s_lshl_b32 s61, s35, 6
    s_add_u32 s60, s60, s61
    v_add_u32 v11, s60, v11
    ds_read_b64_tr_b16 v[248:249], v11 offset:8192
    ds_read_b64_tr_b16 v[250:251], v11 offset:9216
    s_lshl_b32 s60, s33, 7
    s_lshl_b32 s61, s30, 6
    s_add_u32 s60, s60, s61
    v_lshl_add_u32 v12, v16, 4, s60
    ds_read_b128 v[240:243], v12 offset:1152
    ds_read_b128 v[244:247], v12 offset:1184
    v_and_b32 v17, 31, v1
    v_lshlrev_b32 v17, 10, v17
    v_lshl_add_u32 v17, v16, 4, v17
    s_lshl_b32 s32, s49, 16
    s_lshl_b32 s61, s35, 15
    s_add_u32 s32, s32, s61
    s_lshl_b32 s61, s48, 7
    s_add_u32 s32, s32, s61
    s_lshl_b32 s61, s33, 6
    s_add_u32 s32, s32, s61
    s_lshl_b32 s61, s30, 5
    s_add_u32 s32, s32, s61
    v_cmp_eq_u32 vcc, 0, v88
    s_mul_i32 s60, s49, 176128
    s_add_u32 s60, s60, 10485760
    s_mul_i32 s61, s49, 196608
    s_cmp_eq_u64 vcc, 0
    s_cselect_b32 s60, s61, s60
    s_mul_i32 s18, s35, 88064
    s_sub_u32 s19, 88064, s18
    s_add_u32 s18, s18, s60
    s_add_u32 s19, s19, s60
    s_lshl_b32 s60, s30, 8
    v_xor_b32 v38, s60, v9
    s_lshl_b32 s60, s47, 10
    s_add_u32 s61, s60, s18
    v_add_u32 v11, s61, v9
    s_add_u32 s61, s60, s19
    v_add_u32 v12, s61, v9
    s_add_u32 s28, s34, 17137664
    s_add_u32 s29, s36, 17137664
    v_lshlrev_b32 v16, 3, v6
    s_lshl_b32 s60, s47, 7
    v_xor_b32 v16, s60, v16
    s_waitcnt lgkmcnt(2)
    v_lshlrev_b32 v232, 16, v248
    v_and_b32 v233, 0xffff0000, v248
    v_lshlrev_b32 v234, 16, v249
    v_and_b32 v235, 0xffff0000, v249
    v_lshlrev_b32 v236, 16, v250
    v_and_b32 v237, 0xffff0000, v250
    v_lshlrev_b32 v238, 16, v251
    v_and_b32 v239, 0xffff0000, v251
    s_xor_b32 s60, s46, 0
    s_mul_i32 s60, s60, 14336
    s_add_u32 s60, s60, 16384
    v_add_u32 v248, s60, v9
    s_xor_b32 s60, s46, 1
    s_mul_i32 s60, s60, 14336
    s_add_u32 s60, s60, 16384
    v_add_u32 v249, s60, v9
    s_xor_b32 s60, s46, 2
    s_mul_i32 s60, s60, 14336
    s_add_u32 s60, s60, 16384
    v_add_u32 v250, s60, v9
    s_xor_b32 s60, s46, 3
    s_mul_i32 s60, s60, 14336
    s_add_u32 s60, s60, 16384
    v_add_u32 v251, s60, v9
    s_xor_b32 s60, s46, 4
    s_mul_i32 s60, s60, 14336
    s_add_u32 s60, s60, 16384
    v_add_u32 v252, s60, v9
    s_xor_b32 s60, s46, 5
    s_mul_i32 s60, s60, 14336
    s_add_u32 s60, s60, 16384
    v_add_u32 v253, s60, v9
    s_xor_b32 s60, s46, 6
    s_mul_i32 s60, s60, 14336
    s_add_u32 s60, s60, 16384
    v_add_u32 v254, s60, v9
    s_xor_b32 s60, s46, 7
    s_mul_i32 s60, s60, 14336
    s_add_u32 s60, s60, 16384
    v_add_u32 v255, s60, v9
    s_waitcnt vmcnt(0)
    s_barrier
    ds_read_b128 v[40:43], v10 offset:0
    ds_read_b128 v[44:47], v18 offset:0
    ds_read_b128 v[48:51], v19 offset:0
    ds_read_b128 v[52:55], v37 offset:0
    s_waitcnt lgkmcnt(3)
    v_mfma_f32_16x16x32_bf16 v[72:75], v[224:227], v[40:43], 0
    ds_read_b128 v[56:59], v10 offset:4096
    s_waitcnt lgkmcnt(3)
    v_mfma_f32_16x16x32_bf16 v[76:79], v[224:227], v[44:47], 0
    ds_read_b128 v[60:63], v18 offset:4096
    s_waitcnt lgkmcnt(3)
    v_mfma_f32_16x16x32_bf16 v[80:83], v[224:227], v[48:51], 0
    ds_read_b128 v[64:67], v19 offset:4096
    s_waitcnt lgkmcnt(3)
    v_mfma_f32_16x16x32_bf16 v[84:87], v[224:227], v[52:55], 0
    ds_read_b128 v[68:71], v37 offset:4096
    s_add_u32 m0, s52, 32768
    s_nop 0
    buffer_load_dwordx4 v9, s[40:43], s10 offen sc1 lds
    v_mfma_f32_16x16x32_bf16 v[88:91], v[228:231], v[40:43], 0
    v_mfma_f32_16x16x32_bf16 v[92:95], v[228:231], v[44:47], 0
    v_mfma_f32_16x16x32_bf16 v[96:99], v[228:231], v[48:51], 0
    v_mfma_f32_16x16x32_bf16 v[100:103], v[228:231], v[52:55], 0
    s_add_u32 m0, s52, 40960
    s_nop 0
    buffer_load_dwordx4 v9, s[40:43], s11 offen sc1 lds
    s_waitcnt lgkmcnt(3)
    v_mfma_f32_16x16x32_bf16 v[72:75], v[216:219], v[56:59], v[72:75]
    ds_read_b128 v[40:43], v10 offset:8192
    s_waitcnt lgkmcnt(3)
    v_mfma_f32_16x16x32_bf16 v[76:79], v[216:219], v[60:63], v[76:79]
    ds_read_b128 v[44:47], v18 offset:8192
    s_waitcnt lgkmcnt(3)
    v_mfma_f32_16x16x32_bf16 v[80:83], v[216:219], v[64:67], v[80:83]
    ds_read_b128 v[48:51], v19 offset:8192
    s_waitcnt lgkmcnt(3)
    v_mfma_f32_16x16x32_bf16 v[84:87], v[216:219], v[68:71], v[84:87]
    ds_read_b128 v[52:55], v37 offset:8192
    s_add_u32 m0, s52, 49152
    s_nop 0
    buffer_load_dwordx4 v9, s[40:43], s12 offen sc1 lds
    v_mfma_f32_16x16x32_bf16 v[88:91], v[220:223], v[56:59], v[88:91]
    v_mfma_f32_16x16x32_bf16 v[92:95], v[220:223], v[60:63], v[92:95]
    v_mfma_f32_16x16x32_bf16 v[96:99], v[220:223], v[64:67], v[96:99]
    v_mfma_f32_16x16x32_bf16 v[100:103], v[220:223], v[68:71], v[100:103]
    s_add_u32 m0, s52, 57344
    s_nop 0
    buffer_load_dwordx4 v9, s[40:43], s13 offen sc1 lds
    s_waitcnt lgkmcnt(3)
    v_mfma_f32_16x16x32_bf16 v[72:75], v[208:211], v[40:43], v[72:75]
    ds_read_b128 v[56:59], v10 offset:12288
    s_waitcnt lgkmcnt(3)
    v_mfma_f32_16x16x32_bf16 v[76:79], v[208:211], v[44:47], v[76:79]
    ds_read_b128 v[60:63], v18 offset:12288
    s_waitcnt lgkmcnt(3)
    v_mfma_f32_16x16x32_bf16 v[80:83], v[208:211], v[48:51], v[80:83]
    ds_read_b128 v[64:67], v19 offset:12288
    s_waitcnt lgkmcnt(3)
    v_mfma_f32_16x16x32_bf16 v[84:87], v[208:211], v[52:55], v[84:87]
    ds_read_b128 v[68:71], v37 offset:12288
    s_add_u32 m0, s52, 65536
    s_nop 0
    buffer_load_dwordx4 v9, s[40:43], s14 offen sc1 lds
    v_mfma_f32_16x16x32_bf16 v[88:91], v[212:215], v[40:43], v[88:91]
    v_mfma_f32_16x16x32_bf16 v[92:95], v[212:215], v[44:47], v[92:95]
    v_mfma_f32_16x16x32_bf16 v[96:99], v[212:215], v[48:51], v[96:99]
    v_mfma_f32_16x16x32_bf16 v[100:103], v[212:215], v[52:55], v[100:103]
    s_add_u32 m0, s52, 73728
    s_nop 0
    buffer_load_dwordx4 v9, s[40:43], s15 offen sc1 lds
    s_waitcnt vmcnt(4)
    s_barrier
    s_waitcnt lgkmcnt(3)
    v_mfma_f32_16x16x32_bf16 v[72:75], v[200:203], v[56:59], v[72:75]
    ds_read_b128 v[40:43], v10 offset:16384
    s_waitcnt lgkmcnt(3)
    v_mfma_f32_16x16x32_bf16 v[76:79], v[200:203], v[60:63], v[76:79]
    ds_read_b128 v[44:47], v18 offset:16384
    s_waitcnt lgkmcnt(3)
    v_mfma_f32_16x16x32_bf16 v[80:83], v[200:203], v[64:67], v[80:83]
    ds_read_b128 v[48:51], v19 offset:16384
    s_waitcnt lgkmcnt(3)
    v_mfma_f32_16x16x32_bf16 v[84:87], v[200:203], v[68:71], v[84:87]
    ds_read_b128 v[52:55], v37 offset:16384
    v_mfma_f32_16x16x32_bf16 v[88:91], v[204:207], v[56:59], v[88:91]
    v_mfma_f32_16x16x32_bf16 v[92:95], v[204:207], v[60:63], v[92:95]
    v_mfma_f32_16x16x32_bf16 v[96:99], v[204:207], v[64:67], v[96:99]
    v_mfma_f32_16x16x32_bf16 v[100:103], v[204:207], v[68:71], v[100:103]
    s_waitcnt lgkmcnt(3)
    v_mfma_f32_16x16x32_bf16 v[72:75], v[192:195], v[40:43], v[72:75]
    ds_read_b128 v[56:59], v10 offset:20480
    s_waitcnt lgkmcnt(3)
    v_mfma_f32_16x16x32_bf16 v[76:79], v[192:195], v[44:47], v[76:79]
    ds_read_b128 v[60:63], v18 offset:20480
    s_waitcnt lgkmcnt(3)
    v_mfma_f32_16x16x32_bf16 v[80:83], v[192:195], v[48:51], v[80:83]
    ds_read_b128 v[64:67], v19 offset:20480
    s_waitcnt lgkmcnt(3)
    v_mfma_f32_16x16x32_bf16 v[84:87], v[192:195], v[52:55], v[84:87]
    ds_read_b128 v[68:71], v37 offset:20480
    v_mfma_f32_16x16x32_bf16 v[88:91], v[196:199], v[40:43], v[88:91]
    v_mfma_f32_16x16x32_bf16 v[92:95], v[196:199], v[44:47], v[92:95]
    v_mfma_f32_16x16x32_bf16 v[96:99], v[196:199], v[48:51], v[96:99]
    v_mfma_f32_16x16x32_bf16 v[100:103], v[196:199], v[52:55], v[100:103]
    s_waitcnt vmcnt(0)
    s_barrier
    s_waitcnt lgkmcnt(3)
    v_mfma_f32_16x16x32_bf16 v[72:75], v[184:187], v[56:59], v[72:75]
    ds_read_b128 v[40:43], v10 offset:24576
    s_waitcnt lgkmcnt(3)
    v_mfma_f32_16x16x32_bf16 v[76:79], v[184:187], v[60:63], v[76:79]
    ds_read_b128 v[44:47], v18 offset:24576
    s_waitcnt lgkmcnt(3)
    v_mfma_f32_16x16x32_bf16 v[80:83], v[184:187], v[64:67], v[80:83]
    ds_read_b128 v[48:51], v19 offset:24576
    s_waitcnt lgkmcnt(3)
    v_mfma_f32_16x16x32_bf16 v[84:87], v[184:187], v[68:71], v[84:87]
    ds_read_b128 v[52:55], v37 offset:24576
    v_mfma_f32_16x16x32_bf16 v[88:91], v[188:191], v[56:59], v[88:91]
    v_mfma_f32_16x16x32_bf16 v[92:95], v[188:191], v[60:63], v[92:95]
    v_mfma_f32_16x16x32_bf16 v[96:99], v[188:191], v[64:67], v[96:99]
    v_mfma_f32_16x16x32_bf16 v[100:103], v[188:191], v[68:71], v[100:103]
    s_waitcnt lgkmcnt(3)
    v_mfma_f32_16x16x32_bf16 v[72:75], v[176:179], v[40:43], v[72:75]
    ds_read_b128 v[56:59], v10 offset:28672
    s_waitcnt lgkmcnt(3)
    v_mfma_f32_16x16x32_bf16 v[76:79], v[176:179], v[44:47], v[76:79]
    ds_read_b128 v[60:63], v18 offset:28672
    s_waitcnt lgkmcnt(3)
    v_mfma_f32_16x16x32_bf16 v[80:83], v[176:179], v[48:51], v[80:83]
    ds_read_b128 v[64:67], v19 offset:28672
    s_waitcnt lgkmcnt(3)
    v_mfma_f32_16x16x32_bf16 v[84:87], v[176:179], v[52:55], v[84:87]
    ds_read_b128 v[68:71], v37 offset:28672
    v_mfma_f32_16x16x32_bf16 v[88:91], v[180:183], v[40:43], v[88:91]
    v_mfma_f32_16x16x32_bf16 v[92:95], v[180:183], v[44:47], v[92:95]
    v_mfma_f32_16x16x32_bf16 v[96:99], v[180:183], v[48:51], v[96:99]
    v_mfma_f32_16x16x32_bf16 v[100:103], v[180:183], v[52:55], v[100:103]
    s_waitcnt lgkmcnt(3)
    v_mfma_f32_16x16x32_bf16 v[72:75], v[168:171], v[56:59], v[72:75]
    ds_read_b128 v[40:43], v10 offset:32768
    s_waitcnt lgkmcnt(3)
    v_mfma_f32_16x16x32_bf16 v[76:79], v[168:171], v[60:63], v[76:79]
    ds_read_b128 v[44:47], v18 offset:32768
    s_waitcnt lgkmcnt(3)
    v_mfma_f32_16x16x32_bf16 v[80:83], v[168:171], v[64:67], v[80:83]
    ds_read_b128 v[48:51], v19 offset:32768
    s_waitcnt lgkmcnt(3)
    v_mfma_f32_16x16x32_bf16 v[84:87], v[168:171], v[68:71], v[84:87]
    ds_read_b128 v[52:55], v37 offset:32768
    v_mfma_f32_16x16x32_bf16 v[88:91], v[172:175], v[56:59], v[88:91]
    v_mfma_f32_16x16x32_bf16 v[92:95], v[172:175], v[60:63], v[92:95]
    v_mfma_f32_16x16x32_bf16 v[96:99], v[172:175], v[64:67], v[96:99]
    v_mfma_f32_16x16x32_bf16 v[100:103], v[172:175], v[68:71], v[100:103]
    s_waitcnt lgkmcnt(3)
    v_mfma_f32_16x16x32_bf16 v[72:75], v[160:163], v[40:43], v[72:75]
    ds_read_b128 v[56:59], v10 offset:36864
    s_waitcnt lgkmcnt(3)
    v_mfma_f32_16x16x32_bf16 v[76:79], v[160:163], v[44:47], v[76:79]
    ds_read_b128 v[60:63], v18 offset:36864
    s_waitcnt lgkmcnt(3)
    v_mfma_f32_16x16x32_bf16 v[80:83], v[160:163], v[48:51], v[80:83]
    ds_read_b128 v[64:67], v19 offset:36864
    s_waitcnt lgkmcnt(3)
    v_mfma_f32_16x16x32_bf16 v[84:87], v[160:163], v[52:55], v[84:87]
    ds_read_b128 v[68:71], v37 offset:36864
    v_mfma_f32_16x16x32_bf16 v[88:91], v[164:167], v[40:43], v[88:91]
    v_mfma_f32_16x16x32_bf16 v[92:95], v[164:167], v[44:47], v[92:95]
    v_mfma_f32_16x16x32_bf16 v[96:99], v[164:167], v[48:51], v[96:99]
    v_mfma_f32_16x16x32_bf16 v[100:103], v[164:167], v[52:55], v[100:103]
    s_waitcnt lgkmcnt(3)
    v_mfma_f32_16x16x32_bf16 v[72:75], v[152:155], v[56:59], v[72:75]
    ds_read_b128 v[40:43], v10 offset:40960
    s_waitcnt lgkmcnt(3)
    v_mfma_f32_16x16x32_bf16 v[76:79], v[152:155], v[60:63], v[76:79]
    ds_read_b128 v[44:47], v18 offset:40960
    s_waitcnt lgkmcnt(3)
    v_mfma_f32_16x16x32_bf16 v[80:83], v[152:155], v[64:67], v[80:83]
    ds_read_b128 v[48:51], v19 offset:40960
    s_waitcnt lgkmcnt(3)
    v_mfma_f32_16x16x32_bf16 v[84:87], v[152:155], v[68:71], v[84:87]
    ds_read_b128 v[52:55], v37 offset:40960
    v_mfma_f32_16x16x32_bf16 v[88:91], v[156:159], v[56:59], v[88:91]
    v_mfma_f32_16x16x32_bf16 v[92:95], v[156:159], v[60:63], v[92:95]
    v_mfma_f32_16x16x32_bf16 v[96:99], v[156:159], v[64:67], v[96:99]
    v_mfma_f32_16x16x32_bf16 v[100:103], v[156:159], v[68:71], v[100:103]
    s_waitcnt lgkmcnt(3)
    v_mfma_f32_16x16x32_bf16 v[72:75], v[144:147], v[40:43], v[72:75]
    ds_read_b128 v[56:59], v10 offset:45056
    s_waitcnt lgkmcnt(3)
    v_mfma_f32_16x16x32_bf16 v[76:79], v[144:147], v[44:47], v[76:79]
    ds_read_b128 v[60:63], v18 offset:45056
    s_waitcnt lgkmcnt(3)
    v_mfma_f32_16x16x32_bf16 v[80:83], v[144:147], v[48:51], v[80:83]
    ds_read_b128 v[64:67], v19 offset:45056
    s_waitcnt lgkmcnt(3)
    v_mfma_f32_16x16x32_bf16 v[84:87], v[144:147], v[52:55], v[84:87]
    ds_read_b128 v[68:71], v37 offset:45056
    v_mfma_f32_16x16x32_bf16 v[88:91], v[148:151], v[40:43], v[88:91]
    v_mfma_f32_16x16x32_bf16 v[92:95], v[148:151], v[44:47], v[92:95]
    v_mfma_f32_16x16x32_bf16 v[96:99], v[148:151], v[48:51], v[96:99]
    v_mfma_f32_16x16x32_bf16 v[100:103], v[148:151], v[52:55], v[100:103]
    s_waitcnt lgkmcnt(3)
    v_mfma_f32_16x16x32_bf16 v[72:75], v[136:139], v[56:59], v[72:75]
    ds_read_b128 v[40:43], v10 offset:49152
    s_waitcnt lgkmcnt(3)
    v_mfma_f32_16x16x32_bf16 v[76:79], v[136:139], v[60:63], v[76:79]
    ds_read_b128 v[44:47], v18 offset:49152
    s_waitcnt lgkmcnt(3)
    v_mfma_f32_16x16x32_bf16 v[80:83], v[136:139], v[64:67], v[80:83]
    ds_read_b128 v[48:51], v19 offset:49152
    s_waitcnt lgkmcnt(3)
    v_mfma_f32_16x16x32_bf16 v[84:87], v[136:139], v[68:71], v[84:87]
    ds_read_b128 v[52:55], v37 offset:49152
    v_mfma_f32_16x16x32_bf16 v[88:91], v[140:143], v[56:59], v[88:91]
    v_mfma_f32_16x16x32_bf16 v[92:95], v[140:143], v[60:63], v[92:95]
    v_mfma_f32_16x16x32_bf16 v[96:99], v[140:143], v[64:67], v[96:99]
    v_mfma_f32_16x16x32_bf16 v[100:103], v[140:143], v[68:71], v[100:103]
    s_waitcnt lgkmcnt(3)
    v_mfma_f32_16x16x32_bf16 v[72:75], v[128:131], v[40:43], v[72:75]
    ds_read_b128 v[56:59], v10 offset:53248
    s_waitcnt lgkmcnt(3)
    v_mfma_f32_16x16x32_bf16 v[76:79], v[128:131], v[44:47], v[76:79]
    ds_read_b128 v[60:63], v18 offset:53248
    s_waitcnt lgkmcnt(3)
    v_mfma_f32_16x16x32_bf16 v[80:83], v[128:131], v[48:51], v[80:83]
    ds_read_b128 v[64:67], v19 offset:53248
    s_waitcnt lgkmcnt(3)
    v_mfma_f32_16x16x32_bf16 v[84:87], v[128:131], v[52:55], v[84:87]
    ds_read_b128 v[68:71], v37 offset:53248
    v_mfma_f32_16x16x32_bf16 v[88:91], v[132:135], v[40:43], v[88:91]
    v_mfma_f32_16x16x32_bf16 v[92:95], v[132:135], v[44:47], v[92:95]
    v_mfma_f32_16x16x32_bf16 v[96:99], v[132:135], v[48:51], v[96:99]
    v_mfma_f32_16x16x32_bf16 v[100:103], v[132:135], v[52:55], v[100:103]
    s_waitcnt lgkmcnt(3)
    v_mfma_f32_16x16x32_bf16 v[72:75], v[120:123], v[56:59], v[72:75]
    ds_read_b128 v[40:43], v10 offset:57344
    s_waitcnt lgkmcnt(3)
    v_mfma_f32_16x16x32_bf16 v[76:79], v[120:123], v[60:63], v[76:79]
    ds_read_b128 v[44:47], v18 offset:57344
    s_waitcnt lgkmcnt(3)
    v_mfma_f32_16x16x32_bf16 v[80:83], v[120:123], v[64:67], v[80:83]
    ds_read_b128 v[48:51], v19 offset:57344
    s_waitcnt lgkmcnt(3)
    v_mfma_f32_16x16x32_bf16 v[84:87], v[120:123], v[68:71], v[84:87]
    ds_read_b128 v[52:55], v37 offset:57344
    v_mfma_f32_16x16x32_bf16 v[88:91], v[124:127], v[56:59], v[88:91]
    v_mfma_f32_16x16x32_bf16 v[92:95], v[124:127], v[60:63], v[92:95]
    v_mfma_f32_16x16x32_bf16 v[96:99], v[124:127], v[64:67], v[96:99]
    v_mfma_f32_16x16x32_bf16 v[100:103], v[124:127], v[68:71], v[100:103]
    s_waitcnt lgkmcnt(3)
    v_mfma_f32_16x16x32_bf16 v[72:75], v[112:115], v[40:43], v[72:75]
    ds_read_b128 v[56:59], v10 offset:61440
    s_waitcnt lgkmcnt(3)
    v_mfma_f32_16x16x32_bf16 v[76:79], v[112:115], v[44:47], v[76:79]
    ds_read_b128 v[60:63], v18 offset:61440
    s_waitcnt lgkmcnt(3)
    v_mfma_f32_16x16x32_bf16 v[80:83], v[112:115], v[48:51], v[80:83]
    ds_read_b128 v[64:67], v19 offset:61440
    s_waitcnt lgkmcnt(3)
    v_mfma_f32_16x16x32_bf16 v[84:87], v[112:115], v[52:55], v[84:87]
    ds_read_b128 v[68:71], v37 offset:61440
    v_mfma_f32_16x16x32_bf16 v[88:91], v[116:119], v[40:43], v[88:91]
    v_mfma_f32_16x16x32_bf16 v[92:95], v[116:119], v[44:47], v[92:95]
    v_mfma_f32_16x16x32_bf16 v[96:99], v[116:119], v[48:51], v[96:99]
    v_mfma_f32_16x16x32_bf16 v[100:103], v[116:119], v[52:55], v[100:103]
    s_waitcnt lgkmcnt(3)
    v_mfma_f32_16x16x32_bf16 v[72:75], v[104:107], v[56:59], v[72:75]
    s_waitcnt lgkmcnt(2)
    v_mfma_f32_16x16x32_bf16 v[76:79], v[104:107], v[60:63], v[76:79]
    s_waitcnt lgkmcnt(1)
    v_mfma_f32_16x16x32_bf16 v[80:83], v[104:107], v[64:67], v[80:83]
    s_waitcnt lgkmcnt(0)
    v_mfma_f32_16x16x32_bf16 v[84:87], v[104:107], v[68:71], v[84:87]
    v_mfma_f32_16x16x32_bf16 v[88:91], v[108:111], v[56:59], v[88:91]
    v_mfma_f32_16x16x32_bf16 v[92:95], v[108:111], v[60:63], v[92:95]
    v_mfma_f32_16x16x32_bf16 v[96:99], v[108:111], v[64:67], v[96:99]
    v_mfma_f32_16x16x32_bf16 v[100:103], v[108:111], v[68:71], v[100:103]
    buffer_load_dwordx4 v[224:227], v15, s[40:43], s91 offen sc1
    buffer_load_dwordx4 v[228:231], v36, s[40:43], s91 offen sc1
    buffer_load_dwordx4 v[216:219], v15, s[40:43], s92 offen sc1
    buffer_load_dwordx4 v[220:223], v36, s[40:43], s92 offen sc1
    buffer_load_dwordx4 v[208:211], v15, s[40:43], s93 offen sc1
    buffer_load_dwordx4 v[212:215], v36, s[40:43], s93 offen sc1
    buffer_load_dwordx4 v[200:203], v15, s[40:43], s94 offen sc1
    buffer_load_dwordx4 v[204:207], v36, s[40:43], s94 offen sc1
    v_xor_b32 v43, 0x80, v16
    v_xor_b32 v44, 0x100, v16
    v_xor_b32 v45, 0x180, v16
    s_waitcnt lgkmcnt(0)
    s_barrier
    ds_read_b64 v[50:51], v16 offset:640
    ds_read_b64 v[52:53], v43 offset:640
    ds_read_b64 v[54:55], v44 offset:640
    ds_read_b64 v[56:57], v45 offset:640
    s_waitcnt lgkmcnt(3)
    v_pk_fma_f32 v[58:59], v[50:51], v[20:21], v[28:29] op_sel_hi:[0,1,1]
    v_pk_fma_f32 v[60:61], v[50:51], v[22:23], v[30:31] op_sel_hi:[0,1,1]
    v_pk_fma_f32 v[72:73], v[72:73], v[50:51], v[58:59] op_sel:[0,1,0] op_sel_hi:[1,1,1]
    v_pk_fma_f32 v[74:75], v[74:75], v[50:51], v[60:61] op_sel:[0,1,0] op_sel_hi:[1,1,1]
    v_cvt_pk_bf16_f32 v72, v72, v73
    v_cvt_pk_bf16_f32 v73, v74, v75
    v_pk_max_i16 v72, v72, 0
    v_pk_max_i16 v73, v73, 0
    s_waitcnt lgkmcnt(2)
    v_pk_fma_f32 v[58:59], v[52:53], v[20:21], v[28:29] op_sel_hi:[0,1,1]
    v_pk_fma_f32 v[60:61], v[52:53], v[22:23], v[30:31] op_sel_hi:[0,1,1]
    v_pk_fma_f32 v[76:77], v[76:77], v[52:53], v[58:59] op_sel:[0,1,0] op_sel_hi:[1,1,1]
    v_pk_fma_f32 v[78:79], v[78:79], v[52:53], v[60:61] op_sel:[0,1,0] op_sel_hi:[1,1,1]
    v_cvt_pk_bf16_f32 v74, v76, v77
    v_cvt_pk_bf16_f32 v75, v78, v79
    v_pk_max_i16 v74, v74, 0
    v_pk_max_i16 v75, v75, 0
    s_add_u32 s66, s18, s58
    s_nop 0
    v_permlane16_swap_b32 v72, v74
    v_permlane16_swap_b32 v73, v75
    buffer_store_dwordx4 v[72:75], v38, s[40:43], s66 offen
    s_waitcnt lgkmcnt(1)
    v_pk_fma_f32 v[58:59], v[54:55], v[20:21], v[28:29] op_sel_hi:[0,1,1]
    v_pk_fma_f32 v[60:61], v[54:55], v[22:23], v[30:31] op_sel_hi:[0,1,1]
    v_pk_fma_f32 v[80:81], v[80:81], v[54:55], v[58:59] op_sel:[0,1,0] op_sel_hi:[1,1,1]
    v_pk_fma_f32 v[82:83], v[82:83], v[54:55], v[60:61] op_sel:[0,1,0] op_sel_hi:[1,1,1]
    v_cvt_pk_bf16_f32 v80, v80, v81
    v_cvt_pk_bf16_f32 v81, v82, v83
    v_pk_max_i16 v80, v80, 0
    v_pk_max_i16 v81, v81, 0
    s_waitcnt lgkmcnt(0)
    v_pk_fma_f32 v[58:59], v[56:57], v[20:21], v[28:29] op_sel_hi:[0,1,1]
    v_pk_fma_f32 v[60:61], v[56:57], v[22:23], v[30:31] op_sel_hi:[0,1,1]
    v_pk_fma_f32 v[84:85], v[84:85], v[56:57], v[58:59] op_sel:[0,1,0] op_sel_hi:[1,1,1]
    v_pk_fma_f32 v[86:87], v[86:87], v[56:57], v[60:61] op_sel:[0,1,0] op_sel_hi:[1,1,1]
    v_cvt_pk_bf16_f32 v82, v84, v85
    v_cvt_pk_bf16_f32 v83, v86, v87
    v_pk_max_i16 v82, v82, 0
    v_pk_max_i16 v83, v83, 0
    s_add_u32 s66, s19, s58
    s_nop 0
    v_permlane16_swap_b32 v80, v82
    v_permlane16_swap_b32 v81, v83
    buffer_store_dwordx4 v[80:83], v38, s[40:43], s66 offen
    v_pk_fma_f32 v[58:59], v[50:51], v[24:25], v[32:33] op_sel_hi:[0,1,1]
    v_pk_fma_f32 v[60:61], v[50:51], v[26:27], v[34:35] op_sel_hi:[0,1,1]
    v_pk_fma_f32 v[88:89], v[88:89], v[50:51], v[58:59] op_sel:[0,1,0] op_sel_hi:[1,1,1]
    v_pk_fma_f32 v[90:91], v[90:91], v[50:51], v[60:61] op_sel:[0,1,0] op_sel_hi:[1,1,1]
    v_cvt_pk_bf16_f32 v88, v88, v89
    v_cvt_pk_bf16_f32 v89, v90, v91
    v_pk_max_i16 v88, v88, 0
    v_pk_max_i16 v89, v89, 0
    v_pk_fma_f32 v[58:59], v[52:53], v[24:25], v[32:33] op_sel_hi:[0,1,1]
    v_pk_fma_f32 v[60:61], v[52:53], v[26:27], v[34:35] op_sel_hi:[0,1,1]
    v_pk_fma_f32 v[92:93], v[92:93], v[52:53], v[58:59] op_sel:[0,1,0] op_sel_hi:[1,1,1]
    v_pk_fma_f32 v[94:95], v[94:95], v[52:53], v[60:61] op_sel:[0,1,0] op_sel_hi:[1,1,1]
    v_cvt_pk_bf16_f32 v90, v92, v93
    v_cvt_pk_bf16_f32 v91, v94, v95
    v_pk_max_i16 v90, v90, 0
    v_pk_max_i16 v91, v91, 0
    s_add_u32 s66, s18, s59
    s_nop 0
    v_permlane16_swap_b32 v88, v90
    v_permlane16_swap_b32 v89, v91
    buffer_store_dwordx4 v[88:91], v38, s[40:43], s66 offen
    v_pk_fma_f32 v[58:59], v[54:55], v[24:25], v[32:33] op_sel_hi:[0,1,1]
    v_pk_fma_f32 v[60:61], v[54:55], v[26:27], v[34:35] op_sel_hi:[0,1,1]
    v_pk_fma_f32 v[96:97], v[96:97], v[54:55], v[58:59] op_sel:[0,1,0] op_sel_hi:[1,1,1]
    v_pk_fma_f32 v[98:99], v[98:99], v[54:55], v[60:61] op_sel:[0,1,0] op_sel_hi:[1,1,1]
    v_cvt_pk_bf16_f32 v96, v96, v97
    v_cvt_pk_bf16_f32 v97, v98, v99
    v_pk_max_i16 v96, v96, 0
    v_pk_max_i16 v97, v97, 0
    v_pk_fma_f32 v[58:59], v[56:57], v[24:25], v[32:33] op_sel_hi:[0,1,1]
    v_pk_fma_f32 v[60:61], v[56:57], v[26:27], v[34:35] op_sel_hi:[0,1,1]
    v_pk_fma_f32 v[100:101], v[100:101], v[56:57], v[58:59] op_sel:[0,1,0] op_sel_hi:[1,1,1]
    v_pk_fma_f32 v[102:103], v[102:103], v[56:57], v[60:61] op_sel:[0,1,0] op_sel_hi:[1,1,1]
    v_cvt_pk_bf16_f32 v98, v100, v101
    v_cvt_pk_bf16_f32 v99, v102, v103
    v_pk_max_i16 v98, v98, 0
    v_pk_max_i16 v99, v99, 0
    s_add_u32 s66, s19, s59
    s_nop 0
    v_permlane16_swap_b32 v96, v98
    v_permlane16_swap_b32 v97, v99
    buffer_store_dwordx4 v[96:99], v38, s[40:43], s66 offen
    buffer_load_dwordx4 v[192:195], v15, s[40:43], s95 offen sc1
    buffer_load_dwordx4 v[196:199], v36, s[40:43], s95 offen sc1
    s_waitcnt vmcnt(2)
    v_mov_b32 v4, 1
    s_mov_b64 exec, 1
    ds_add_rtn_u32 v4, v5, v4 offset:52
    s_mov_b64 exec, -1
    s_waitcnt lgkmcnt(0)
    v_readfirstlane_b32 s63, v4
    s_cmp_eq_u32 s63, 7
    s_cselect_b32 s28, s28, 1073741824
    s_cmp_eq_u32 s51, 0
    s_cbranch_scc1 .slow_87
    buffer_store_dword v39, v5, s[40:43], s28 offen
    s_branch .pubd_88
.slow_87:
    buffer_wbl2 sc1
    s_waitcnt vmcnt(0)
    buffer_store_dword v39, v5, s[40:43], s28 offen sc1
.pubd_88:
    buffer_load_dwordx4 v[184:187], v15, s[40:43], s96 offen sc1
    buffer_load_dwordx4 v[188:191], v36, s[40:43], s96 offen sc1
    buffer_load_dwordx4 v[176:179], v15, s[40:43], s97 offen sc1
    buffer_load_dwordx4 v[180:183], v36, s[40:43], s97 offen sc1
    buffer_load_dwordx4 v[168:171], v15, s[40:43], s98 offen sc1
    buffer_load_dwordx4 v[172:175], v36, s[40:43], s98 offen sc1
    buffer_load_dwordx4 v[160:163], v15, s[40:43], s99 offen sc1
    buffer_load_dwordx4 v[164:167], v36, s[40:43], s99 offen sc1
    buffer_load_dword v4, v8, s[40:43], s29 offen sc1
    s_waitcnt vmcnt(0)
    s_mov_b32 s63, 0
    v_cmp_ne_u32 vcc, s62, v4
    s_cbranch_vccz .pok_89
    s_mov_b32 s63, 0
.poll_90:
    buffer_load_dword v4, v8, s[40:43], s29 offen sc1
    s_add_u32 s63, s63, 1
    s_cmp_gt_u32 s63, 262144
    s_cbranch_scc1 .pollx_91
    s_waitcnt vmcnt(0)
    v_cmp_ne_u32 vcc, s62, v4
    s_cbranch_vccz .pollx_91
    s_sleep 1
    s_branch .poll_90
.pollx_91:
.pok_89:
    buffer_load_dwordx4 v[104:107], v11, s[40:43], s91 offen sc1
    buffer_load_dwordx4 v[108:111], v12, s[40:43], s91 offen sc1
    buffer_load_dwordx4 v[112:115], v11, s[40:43], s92 offen sc1
    buffer_load_dwordx4 v[116:119], v12, s[40:43], s92 offen sc1
    s_waitcnt vmcnt(2)
    v_mfma_f32_32x32x16_bf16 v[40:55], v[224:227], v[104:107], 0
    buffer_load_dwordx4 v[120:123], v11, s[40:43], s93 offen sc1
    v_mfma_f32_32x32x16_bf16 v[56:71], v[224:227], v[108:111], 0
    buffer_load_dwordx4 v[124:127], v12, s[40:43], s93 offen sc1
    v_mfma_f32_32x32x16_bf16 v[72:87], v[228:231], v[104:107], 0
    v_mfma_f32_32x32x16_bf16 v[88:103], v[228:231], v[108:111], 0
    s_waitcnt vmcnt(2)
    v_mfma_f32_32x32x16_bf16 v[40:55], v[216:219], v[112:115], v[40:55]
    buffer_load_dwordx4 v[128:131], v11, s[40:43], s94 offen sc1
    v_mfma_f32_32x32x16_bf16 v[56:71], v[216:219], v[116:119], v[56:71]
    buffer_load_dwordx4 v[132:135], v12, s[40:43], s94 offen sc1
    v_mfma_f32_32x32x16_bf16 v[72:87], v[220:223], v[112:115], v[72:87]
    v_mfma_f32_32x32x16_bf16 v[88:103], v[220:223], v[116:119], v[88:103]
    s_waitcnt vmcnt(2)
    v_mfma_f32_32x32x16_bf16 v[40:55], v[208:211], v[120:123], v[40:55]
    buffer_load_dwordx4 v[136:139], v11, s[40:43], s95 offen sc1
    v_mfma_f32_32x32x16_bf16 v[56:71], v[208:211], v[124:127], v[56:71]
    buffer_load_dwordx4 v[140:143], v12, s[40:43], s95 offen sc1
    v_mfma_f32_32x32x16_bf16 v[72:87], v[212:215], v[120:123], v[72:87]
    v_mfma_f32_32x32x16_bf16 v[88:103], v[212:215], v[124:127], v[88:103]
    s_waitcnt vmcnt(2)
    v_mfma_f32_32x32x16_bf16 v[40:55], v[200:203], v[128:131], v[40:55]
    buffer_load_dwordx4 v[144:147], v11, s[40:43], s96 offen sc1
    v_mfma_f32_32x32x16_bf16 v[56:71], v[200:203], v[132:135], v[56:71]
    buffer_load_dwordx4 v[148:151], v12, s[40:43], s96 offen sc1
    v_mfma_f32_32x32x16_bf16 v[72:87], v[204:207], v[128:131], v[72:87]
    v_mfma_f32_32x32x16_bf16 v[88:103], v[204:207], v[132:135], v[88:103]
    s_waitcnt vmcnt(2)
    v_mfma_f32_32x32x16_bf16 v[40:55], v[192:195], v[136:139], v[40:55]
    buffer_load_dwordx4 v[104:107], v11, s[40:43], s97 offen sc1
    v_mfma_f32_32x32x16_bf16 v[56:71], v[192:195], v[140:143], v[56:71]
    buffer_load_dwordx4 v[108:111], v12, s[40:43], s97 offen sc1
    v_mfma_f32_32x32x16_bf16 v[72:87], v[196:199], v[136:139], v[72:87]
    v_mfma_f32_32x32x16_bf16 v[88:103], v[196:199], v[140:143], v[88:103]
    s_waitcnt vmcnt(2)
    v_mfma_f32_32x32x16_bf16 v[40:55], v[184:187], v[144:147], v[40:55]
    buffer_load_dwordx4 v[112:115], v11, s[40:43], s98 offen sc1
    v_mfma_f32_32x32x16_bf16 v[56:71], v[184:187], v[148:151], v[56:71]
    buffer_load_dwordx4 v[116:119], v12, s[40:43], s98 offen sc1
    v_mfma_f32_32x32x16_bf16 v[72:87], v[188:191], v[144:147], v[72:87]
    v_mfma_f32_32x32x16_bf16 v[88:103], v[188:191], v[148:151], v[88:103]
    s_waitcnt vmcnt(2)
    v_mfma_f32_32x32x16_bf16 v[40:55], v[176:179], v[104:107], v[40:55]
    buffer_load_dwordx4 v[120:123], v11, s[40:43], s99 offen sc1
    v_mfma_f32_32x32x16_bf16 v[56:71], v[176:179], v[108:111], v[56:71]
    buffer_load_dwordx4 v[124:127], v12, s[40:43], s99 offen sc1
    v_mfma_f32_32x32x16_bf16 v[72:87], v[180:183], v[104:107], v[72:87]
    v_mfma_f32_32x32x16_bf16 v[88:103], v[180:183], v[108:111], v[88:103]
    s_waitcnt vmcnt(2)
    v_mfma_f32_32x32x16_bf16 v[40:55], v[168:171], v[112:115], v[40:55]
    v_mfma_f32_32x32x16_bf16 v[56:71], v[168:171], v[116:119], v[56:71]
    v_mfma_f32_32x32x16_bf16 v[72:87], v[172:175], v[112:115], v[72:87]
    v_mfma_f32_32x32x16_bf16 v[88:103], v[172:175], v[116:119], v[88:103]
    s_waitcnt vmcnt(0)
    v_mfma_f32_32x32x16_bf16 v[40:55], v[160:163], v[120:123], v[40:55]
    v_mfma_f32_32x32x16_bf16 v[56:71], v[160:163], v[124:127], v[56:71]
    v_mfma_f32_32x32x16_bf16 v[72:87], v[164:167], v[120:123], v[72:87]
    v_mfma_f32_32x32x16_bf16 v[88:103], v[164:167], v[124:127], v[88:103]
    s_nop 8
    ds_write_b128 v249, v[48:51] offset:0
    ds_write_b128 v249, v[52:55] offset:1024
    ds_write_b128 v250, v[56:59] offset:2048
    ds_write_b128 v250, v[60:63] offset:3072
    ds_write_b128 v251, v[64:67] offset:4096
    ds_write_b128 v251, v[68:71] offset:5120
    ds_write_b128 v252, v[72:75] offset:6144
    ds_write_b128 v252, v[76:79] offset:7168
    ds_write_b128 v253, v[80:83] offset:8192
    ds_write_b128 v253, v[84:87] offset:9216
    ds_write_b128 v254, v[88:91] offset:10240
    ds_write_b128 v254, v[92:95] offset:11264
    ds_write_b128 v255, v[96:99] offset:12288
    ds_write_b128 v255, v[100:103] offset:13312
.join_3:
    s_mov_b32 s36, s24
    s_mov_b32 s37, s25
    s_mov_b32 s38, 0x200000
    s_mov_b32 s39, 0x20000
    s_waitcnt lgkmcnt(0)
    s_barrier
    ds_read_b128 v[48:51], v248 offset:0
    ds_read_b128 v[52:55], v248 offset:1024
    ds_read_b128 v[56:59], v248 offset:2048
    ds_read_b128 v[60:63], v248 offset:3072
    ds_read_b128 v[64:67], v248 offset:4096
    ds_read_b128 v[68:71], v248 offset:5120
    ds_read_b128 v[72:75], v248 offset:6144
    ds_read_b128 v[76:79], v248 offset:7168
    ds_read_b128 v[80:83], v248 offset:8192
    ds_read_b128 v[84:87], v248 offset:9216
    ds_read_b128 v[88:91], v248 offset:10240
    ds_read_b128 v[92:95], v248 offset:11264
    ds_read_b128 v[96:99], v248 offset:12288
    ds_read_b128 v[100:103], v248 offset:13312
    s_waitcnt lgkmcnt(12)
    v_pk_add_f32 v[40:41], v[40:41], v[48:49]
    v_pk_add_f32 v[42:43], v[42:43], v[50:51]
    v_pk_add_f32 v[44:45], v[44:45], v[52:53]
    v_pk_add_f32 v[46:47], v[46:47], v[54:55]
    s_waitcnt lgkmcnt(10)
    v_pk_add_f32 v[40:41], v[40:41], v[56:57]
    v_pk_add_f32 v[42:43], v[42:43], v[58:59]
    v_pk_add_f32 v[44:45], v[44:45], v[60:61]
    v_pk_add_f32 v[46:47], v[46:47], v[62:63]
    s_waitcnt lgkmcnt(8)
    v_pk_add_f32 v[40:41], v[40:41], v[64:65]
    v_pk_add_f32 v[42:43], v[42:43], v[66:67]
    v_pk_add_f32 v[44:45], v[44:45], v[68:69]
    v_pk_add_f32 v[46:47], v[46:47], v[70:71]
    s_waitcnt lgkmcnt(6)
    v_pk_add_f32 v[40:41], v[40:41], v[72:73]
    v_pk_add_f32 v[42:43], v[42:43], v[74:75]
    v_pk_add_f32 v[44:45], v[44:45], v[76:77]
    v_pk_add_f32 v[46:47], v[46:47], v[78:79]
    s_waitcnt lgkmcnt(4)
    v_pk_add_f32 v[40:41], v[40:41], v[80:81]
    v_pk_add_f32 v[42:43], v[42:43], v[82:83]
    v_pk_add_f32 v[44:45], v[44:45], v[84:85]
    v_pk_add_f32 v[46:47], v[46:47], v[86:87]
    s_waitcnt lgkmcnt(2)
    v_pk_add_f32 v[40:41], v[40:41], v[88:89]
    v_pk_add_f32 v[42:43], v[42:43], v[90:91]
    v_pk_add_f32 v[44:45], v[44:45], v[92:93]
    v_pk_add_f32 v[46:47], v[46:47], v[94:95]
    s_waitcnt lgkmcnt(0)
    v_pk_add_f32 v[40:41], v[40:41], v[96:97]
    v_pk_add_f32 v[42:43], v[42:43], v[98:99]
    v_pk_add_f32 v[44:45], v[44:45], v[100:101]
    v_pk_add_f32 v[46:47], v[46:47], v[102:103]
    v_pk_fma_f32 v[40:41], v[40:41], v[240:241], v[232:233]
    v_pk_fma_f32 v[42:43], v[42:43], v[242:243], v[234:235]
    v_pk_fma_f32 v[44:45], v[44:45], v[244:245], v[236:237]
    v_pk_fma_f32 v[46:47], v[46:47], v[246:247], v[238:239]
    v_cvt_pk_bf16_f32 v48, v40, v41
    v_cvt_pk_bf16_f32 v49, v42, v43
    v_cvt_pk_bf16_f32 v50, v44, v45
    v_cvt_pk_bf16_f32 v51, v46, v47
    s_nop 1
    v_permlane32_swap_b32 v48, v50
    v_permlane32_swap_b32 v49, v51
    buffer_store_dwordx4 v[48:51], v17, s[36:39], s32 offen
.end_1:
.end_1x:
    s_endpgm
.section .rodata,"a"
.p2align 6
.amdhsa_kernel adaLN_cond__ssm_conv_h3__dense_activation_relu__prompt_kernel
  .amdhsa_next_free_vgpr 256
  .amdhsa_next_free_sgpr 102
  .amdhsa_accum_offset 256
  .amdhsa_group_segment_fixed_size 0
  .amdhsa_kernarg_size 112
  .amdhsa_user_sgpr_count 2
  .amdhsa_user_sgpr_kernarg_segment_ptr 1
  .amdhsa_system_sgpr_workgroup_id_x 1
  .amdhsa_float_denorm_mode_32 3
.end_amdhsa_kernel
```
